```python
import torch

def _softmax(x, axis=-1):
    return torch.softmax(x, dim=axis)
def _gelu(x):
    return torch.nn.functional.gelu(x, approximate="tanh")
def _silu(x):
    return torch.nn.functional.silu(x)
def _sigmoid(x):
    return torch.sigmoid(x)
def _layernorm(x, axis=-1, eps=1e-5):
    m = x.mean(dim=axis, keepdim=True)
    v = x.var(dim=axis, keepdim=True, unbiased=False)
    return (x - m) / torch.sqrt(v + eps)
def _scatter_add(tgt, idx, src, axis=0):
    return tgt.clone().index_add_(axis, idx, src)
def _segment_sum(src, seg, n):
    out = torch.zeros((n,) + src.shape[1:], dtype=src.dtype)
    return out.index_add_(0, seg, src)
def _pad(x, pw):
    flat = tuple(v for pair in reversed(pw) for v in pair)
    return torch.nn.functional.pad(x, flat)

kernel_name = 'sequential_preLN__sliding_block_cached__dense_activation_squared_relu__decode'

def setup_inputs():

    _w = (lambda a: (lambda t: t.to(torch.bfloat16) if t.is_floating_point() else t)(torch.as_tensor(a)))
    def _A_setup():
        B, Sq, D = 1, 1, 640
        Hq, Hkv, Sk, Dh = 32, 32, 32768, 192
        assert Hq % Hkv == 0, (Hq, Hkv)
        return {
            "x": _w((lambda *s: torch.randn(*s, dtype=torch.bfloat16) * 0.05)(B, Sq, D)),
            "k_cache": _w((lambda *s: torch.randn(*s, dtype=torch.bfloat16) * 3.2)(B, Hkv, Sk, Dh)),
            "v_cache": _w((lambda *s: torch.randn(*s, dtype=torch.bfloat16) * 0.4)(B, Hkv, Sk, Dh)),
            "wq": _w((lambda *s: torch.randn(*s, dtype=torch.bfloat16) * 3.2)(D, Hq * Dh) * (D ** -0.5)),
            "wo": _w((lambda *s: torch.randn(*s, dtype=torch.bfloat16) * 0.4)(Hq * Dh, D) * ((Hq * Dh) ** -0.5)),
        }
    _A_in = _A_setup()

    def _B_setup():
        B, S, D, F = 1, 1, 640, 1536
        return {
            "x": _w((lambda *s: torch.randn(*s, dtype=torch.bfloat16) * 0.05)(B, S, D)),
            "w1": _w((lambda *s: torch.randn(*s, dtype=torch.bfloat16) * 0.05)(D, F)),
            "b1": _w((lambda *s: torch.randn(*s, dtype=torch.bfloat16) * 0.8)(F)),
            "w2": _w((lambda *s: torch.randn(*s, dtype=torch.bfloat16) * 0.05)(F, D)),
            "b2": _w((lambda *s: torch.randn(*s, dtype=torch.bfloat16) * 3.2)(D)),
        }
    _B_in = _B_setup()

    return {
        "A_x": _A_in["x"],
        "A_k_cache": _A_in["k_cache"],
        "A_v_cache": _A_in["v_cache"],
        "A_wq": _A_in["wq"],
        "A_wo": _A_in["wo"],
        "B_x": _B_in["x"],
        "B_w1": _B_in["w1"],
        "B_b1": _B_in["b1"],
        "B_w2": _B_in["w2"],
        "B_b2": _B_in["b2"],
    }

def reference(A_x, A_k_cache, A_v_cache, A_wq, A_wo, B_x, B_w1, B_b1, B_w2, B_b2):
    def _A_ref(x, k_cache, v_cache, wq, wo):
        B, Sq, D = x.shape
        Hq, Dh = 32, 192
        Hkv, Sk = k_cache.shape[1], k_cache.shape[2]
        W = min(4096, max(256, Sk // 4))
        rep = Hq // Hkv
        q = (lambda x, *d: x.permute(*d))((x @ wq).reshape(B, Sq, Hq, Dh), 0, 2, 1, 3)
        k = (lambda x, n, axis: torch.repeat_interleave(x, n, dim=axis))(k_cache[:, :, Sk - W:, :], rep, axis=1)
        v = (lambda x, n, axis: torch.repeat_interleave(x, n, dim=axis))(v_cache[:, :, Sk - W:, :], rep, axis=1)
        scores = torch.einsum("bhqd,bhkd->bhqk", q, k) * (Dh ** -0.5)
        p = _softmax(scores, axis=-1)
        o = torch.einsum("bhqk,bhkd->bhqd", p, v)
        return (lambda x, *d: x.permute(*d))(o, 0, 2, 1, 3).reshape(B, Sq, Hq * Dh) @ wo

    def _B_ref(x, w1, b1, w2, b2):
        h = torch.einsum("bsd,df->bsf", x, w1) + b1
        zero = torch.zeros_like(h)
        r = torch.where(h > zero, h, zero)
        h = r * r
        out = torch.einsum("bsf,fd->bsd", h, w2) + b2
        return out

    x = A_x
    h = x + _A_ref(_layernorm(x, axis=-1), A_k_cache, A_v_cache, A_wq, A_wo)
    h2 = h + _B_ref(_layernorm(h, axis=-1), B_w1, B_b1, B_w2, B_b2)
    return h2
```

```asm
; @launch grid=(256,1,1) block=(512,1,1) lds=17408
.amdgcn_target "amdgcn-amd-amdhsa--gfx950"
.text
.globl sequential_preLN__sliding_block_cached__dense_activation_squared_relu__decode_kernel
.p2align 8
.type sequential_preLN__sliding_block_cached__dense_activation_squared_relu__decode_kernel,@function
sequential_preLN__sliding_block_cached__dense_activation_squared_relu__decode_kernel:
    s_load_dwordx2 s[4:5], s[0:1], 8
    s_load_dwordx2 s[12:13], s[0:1], 96
    v_lshrrev_b32 v7, 6, v0
    s_lshr_b32 s3, s2, 6
    v_readfirstlane_b32 s24, v7
    s_cmp_ge_u32 s3, 4
    s_cbranch_scc1 L_end
    s_and_b32 s27, s2, 7
    s_lshl_b32 s64, s27, 2
    s_add_u32 s25, s64, s3
    s_lshr_b32 s26, s2, 3
    s_add_u32 s64, s64, s26
    s_and_b32 s26, s26, 7
    s_add_u32 s64, s64, s24
    s_lshl_b32 s36, s25, 6
    s_add_u32 s36, s36, 56
    s_add_u32 s65, s36, s26
    s_mul_i32 s65, s65, 196608
    s_and_b32 s32, s64, 31
    s_mul_i32 s32, s32, 6144
    s_add_u32 s40, s65, s32
    v_bfe_u32 v6, v0, 3, 3
    v_and_b32 v7, 7, v0
    v_mul_u32_u24 v12, 24, v6
    v_add_lshl_u32 v1, v12, v7, 4
    s_mov_b32 s6, 402653184
    s_mov_b32 s7, 0x20000
    s_cmp_ge_u32 s24, 4
    s_cbranch_scc1 L_rest
    s_waitcnt lgkmcnt(0)
    buffer_load_dwordx4 v[64:67], v1, s[4:7], s40 offen offset:0 nt
    buffer_load_dwordx4 v[68:71], v1, s[4:7], s40 offen offset:128 nt
    buffer_load_dwordx4 v[72:75], v1, s[4:7], s40 offen offset:256 nt
    buffer_load_dwordx4 v[76:79], v1, s[4:7], s40 offen offset:3072 nt
    buffer_load_dwordx4 v[80:83], v1, s[4:7], s40 offen offset:3200 nt
L_rest:
    s_load_dwordx2 s[8:9], s[0:1], 16
    s_load_dwordx2 s[16:17], s[0:1], 24
    s_load_dwordx2 s[20:21], s[0:1], 0
    v_lshlrev_b32 v12, 4, v0
    v_mov_b32 v8, -1
    v_mov_b32 v9, -1
    v_mov_b32 v10, -1
    v_mov_b32 v11, -1
    ds_write_b128 v12, v[8:11]
    v_and_b32 v0, 63, v0
    s_mov_b32 s10, 402653184
    s_mov_b32 s11, 0x20000
    s_mov_b32 s14, 1610612736
    s_mov_b32 s15, 0x20000
    s_mov_b32 s18, 7864320
    s_mov_b32 s19, 0x20000
    s_mov_b32 s22, 1280
    s_mov_b32 s23, 0x20000
    s_mul_i32 s28, s3, 6
    s_add_u32 s28, s28, s26
    s_cmp_ge_u32 s26, 5
    s_cselect_b32 s32, 2, 0
    s_sub_u32 s28, s28, s32
    s_sub_u32 s32, s26, 3
    s_cmp_lt_u32 s32, 2
    s_cselect_b32 s28, 99, s28
    s_sub_u32 s32, s28, 19
    s_and_b32 s32, s32, -3
    s_cselect_b32 s32, 0, 6
    s_xor_b32 s28, s28, s32
    s_cmp_eq_u32 s27, 0
    s_cselect_b32 s28, s28, 99
    s_add_u32 s64, s64, 4
    s_and_b32 s32, s64, 31
    s_mul_i32 s32, s32, 6144
    s_add_u32 s41, s65, s32
    s_add_u32 s64, s64, 4
    s_and_b32 s32, s64, 31
    s_mul_i32 s32, s32, 6144
    s_add_u32 s42, s65, s32
    s_add_u32 s64, s64, 4
    s_and_b32 s32, s64, 31
    s_mul_i32 s32, s32, 6144
    s_add_u32 s43, s65, s32
    s_mov_b32 s31, 0x100000
    s_movk_i32 s67, 0xff00
    v_and_b32 v12, 1, v6
    v_bfe_u32 v13, v0, 4, 1
    v_lshl_add_u32 v12, v13, 3, v12
    v_lshrrev_b32 v13, 5, v0
    v_lshl_add_u32 v12, v13, 1, v12
    v_mul_u32_u24 v12, 24, v12
    v_add_lshl_u32 v2, v12, v7, 4
    v_bfe_u32 v12, v0, 1, 1
    v_lshlrev_b32 v12, 4, v12
    v_mov_b32 v13, 0xffff
    v_lshlrev_b32 v12, v12, v13
    v_bfe_i32 v13, v0, 3, 1
    v_and_b32 v4, v12, v13
    v_not_b32 v13, v13
    v_and_b32 v3, v12, v13
    v_bfe_u32 v12, v0, 2, 1
    v_and_b32 v13, 1, v0
    v_lshl_add_u32 v12, v12, 1, v13
    v_mul_u32_u24 v5, 0x5555, v12
    s_lshl_b32 s32, s24, 3
    v_mov_b32 v13, s32
    s_waitcnt lgkmcnt(0)
    s_load_dword s66, s[12:13], 393216
    s_barrier
    s_cmp_lt_u32 s24, 4
    s_cbranch_scc1 L_aload
    s_setprio 3
    s_mul_i32 s35, s25, 5632
    s_add_u32 s35, s35, 524288
    s_cmp_eq_u32 s24, 7
    s_cbranch_scc1 L_w7
    s_mov_b32 s29, s25
    s_mov_b32 s30, s26
    s_mov_b32 s38, 1
    s_cmp_lt_u32 s26, 7
    s_cbranch_scc1 L_nopf
    s_getpc_b64 s[56:57]
L_pc:
    s_sub_u32 s32, s24, 4
    s_mul_i32 s32, s32, 4608
    v_mul_u32_u24 v6, 72, v0
    v_add_u32 v6, s32, v6
    v_min_u32 v6, L_end-L_pc, v6
    global_load_dword v26, v6, s[56:57]
    s_and_b32 s29, s25, 3
    s_sub_u32 s30, s27, 1
    s_mov_b32 s38, 7
    s_mul_i32 s35, s29, 5632
    s_add_u32 s35, s35, 524288
L_nopf:
    s_cmp_lg_u32 s27, 0
    s_cbranch_scc1 L_wq
    s_waitcnt vmcnt(0) lgkmcnt(0)
    s_mul_i32 s66, s66, 1664525
    s_add_u32 s66, s66, 1013904223
    s_cmp_lt_u32 s28, 24
    s_cbranch_scc1 L_w1
    s_branch L_bprep
L_w7:
    v_lshlrev_b32 v6, 4, v0
    v_mov_b32 v7, 0
    s_add_u32 s32, s35, 5376
    s_lshl_b32 s3, s26, 2
    v_mov_b32 v15, s3
    s_getreg_b32 s3, hwreg(HW_REG_XCC_ID, 0, 4)
    s_waitcnt lgkmcnt(0)
    s_mul_i32 s66, s66, 1664525
    s_add_u32 s66, s66, 1013904223
    s_andn2_b32 s33, s66, 15
    s_or_b32 s33, s33, s3
    v_mov_b32 v14, s33
    s_mov_b64 exec, 1
    buffer_store_dword v14, v15, s[12:15], s32 offen
    s_mov_b64 exec, -1
    s_setprio 0
    s_cmp_lt_u32 s28, 24
    s_cbranch_scc1 L_w1
    s_branch L_w7b
L_wq:
    v_lshrrev_b32 v6, 4, v0
    v_mul_u32_u24 v6, 48, v6
    v_and_b32 v7, 15, v0
    v_lshl_add_u32 v7, v7, 2, v6
    v_lshlrev_b32 v6, 2, v0
    s_mul_i32 s32, s30, 192
    buffer_load_dword v21, v7, s[20:23], s32 offen
    buffer_load_dword v20, v6, s[20:23], 0 offen offset:1024
    v_lshlrev_b32 v6, 4, v0
    buffer_load_dwordx4 v[16:19], v6, s[20:23], 0 offen
    v_lshrrev_b32 v14, 5, v0
    v_mul_u32_u24 v14, 24, v14
    v_bfe_u32 v15, v0, 3, 2
    v_add_u32 v14, v14, v15
    v_mul_u32_u24 v14, 12288, v14
    v_and_b32 v15, 7, v0
    v_lshl_add_u32 v7, v15, 4, v14
    s_mul_i32 s48, s30, 1179648
    s_mul_i32 s32, s29, 384
    s_add_u32 s48, s48, s32
    s_lshl_b32 s32, s24, 7
    s_add_u32 s48, s48, s32
    s_sub_u32 s48, s48, 512
    s_add_u32 s49, s48, 589824
    buffer_load_dwordx4 v[160:163], v7, s[16:19], s48 offen nt
    s_add_u32 s48, s48, 49152
    buffer_load_dwordx4 v[164:167], v7, s[16:19], s49 offen nt
    s_add_u32 s49, s49, 49152
    buffer_load_dwordx4 v[168:171], v7, s[16:19], s48 offen nt
    s_add_u32 s48, s48, 49152
    buffer_load_dwordx4 v[172:175], v7, s[16:19], s49 offen nt
    s_add_u32 s49, s49, 49152
    buffer_load_dwordx4 v[176:179], v7, s[16:19], s48 offen nt
    s_add_u32 s48, s48, 49152
    s_waitcnt vmcnt(4)
    buffer_load_dwordx4 v[180:183], v7, s[16:19], s49 offen nt
    s_add_u32 s49, s49, 49152
    s_waitcnt vmcnt(4)
    buffer_load_dwordx4 v[184:187], v7, s[16:19], s48 offen nt
    s_add_u32 s48, s48, 49152
    s_waitcnt vmcnt(4)
    buffer_load_dwordx4 v[188:191], v7, s[16:19], s49 offen nt
    s_add_u32 s49, s49, 49152
    s_waitcnt vmcnt(4)
    buffer_load_dwordx4 v[192:195], v7, s[16:19], s48 offen nt
    s_add_u32 s48, s48, 49152
    s_waitcnt vmcnt(4)
    buffer_load_dwordx4 v[196:199], v7, s[16:19], s49 offen nt
    s_add_u32 s49, s49, 49152
    s_waitcnt vmcnt(4)
    buffer_load_dwordx4 v[200:203], v7, s[16:19], s48 offen nt
    s_waitcnt vmcnt(4)
    buffer_load_dwordx4 v[204:207], v7, s[16:19], s49 offen nt
    v_mov_b32 v15, 0x3f803f80
    v_mov_b32 v22, 0
    v_mov_b32 v23, 0
    v_dot2c_f32_bf16 v22, v16, v15
    v_dot2c_f32_bf16 v23, v16, v16
    v_dot2c_f32_bf16 v22, v17, v15
    v_dot2c_f32_bf16 v23, v17, v17
    v_dot2c_f32_bf16 v22, v18, v15
    v_dot2c_f32_bf16 v23, v18, v18
    v_dot2c_f32_bf16 v22, v19, v15
    v_dot2c_f32_bf16 v23, v19, v19
    v_dot2c_f32_bf16 v22, v20, v15
    v_dot2c_f32_bf16 v23, v20, v20
    v_mov_b32 v36, 0
    v_mov_b32 v37, 0
    v_mov_b32 v38, 0
    v_mov_b32 v39, 0
    v_add_f32_dpp v22, v22, v22 quad_perm:[1,0,3,2] row_mask:0xf bank_mask:0xf
    v_add_f32_dpp v23, v23, v23 quad_perm:[1,0,3,2] row_mask:0xf bank_mask:0xf
    s_nop 0
    v_add_f32_dpp v22, v22, v22 quad_perm:[2,3,0,1] row_mask:0xf bank_mask:0xf
    v_add_f32_dpp v23, v23, v23 quad_perm:[2,3,0,1] row_mask:0xf bank_mask:0xf
    s_nop 0
    v_add_f32_dpp v22, v22, v22 row_half_mirror row_mask:0xf bank_mask:0xf
    v_add_f32_dpp v23, v23, v23 row_half_mirror row_mask:0xf bank_mask:0xf
    s_nop 0
    v_add_f32_dpp v22, v22, v22 row_mirror row_mask:0xf bank_mask:0xf
    v_add_f32_dpp v23, v23, v23 row_mirror row_mask:0xf bank_mask:0xf
    s_nop 0
    v_add_f32_dpp v22, v22, v22 row_bcast:15 row_mask:0xa bank_mask:0xf
    v_add_f32_dpp v23, v23, v23 row_bcast:15 row_mask:0xa bank_mask:0xf
    s_nop 0
    v_add_f32_dpp v22, v22, v22 row_bcast:31 row_mask:0xc bank_mask:0xf
    v_add_f32_dpp v23, v23, v23 row_bcast:31 row_mask:0xc bank_mask:0xf
    v_readlane_b32 s32, v22, 63
    v_readlane_b32 s3, v23, 63
    v_lshlrev_b32 v16, 16, v21
    v_and_b32 v17, 0xffff0000, v21
    v_mov_b32 v22, 0x3acccccd
    v_mul_f32 v22, s32, v22
    v_mov_b32 v24, 0x3acccccd
    v_mul_f32 v24, s3, v24
    v_fma_f32 v24, -v22, v22, v24
    v_cvt_pk_bf16_f32 v22, 0, v22
    v_max_f32 v24, 0, v24
    v_cvt_pk_bf16_f32 v24, 0, v24
    v_add_f32 v24, 0x3727c5ac, v24
    v_cvt_pk_bf16_f32 v24, 0, v24
    v_sqrt_f32 v24, v24
    s_nop 0
    v_cvt_pk_bf16_f32 v24, 0, v24
    v_rcp_f32 v24, v24
    v_pk_add_f32 v[16:17], v[16:17], v[22:23] op_sel_hi:[1,0] neg_lo:[0,1] neg_hi:[0,1]
    v_cvt_pk_bf16_f32 v16, 0, v16
    v_cvt_pk_bf16_f32 v17, 0, v17
    v_pk_mul_f32 v[16:17], v[16:17], v[24:25] op_sel_hi:[1,0]
    v_cvt_pk_bf16_f32 v20, v16, v17
    s_nop 1
    v_and_b32_dpp v48, v20, v3 row_newbcast:0 row_mask:0xf bank_mask:0xf
    v_and_b32_dpp v49, v20, v4 row_newbcast:0 row_mask:0xf bank_mask:0xf
    v_and_b32_dpp v50, v20, v3 row_newbcast:1 row_mask:0xf bank_mask:0xf
    v_and_b32_dpp v51, v20, v4 row_newbcast:1 row_mask:0xf bank_mask:0xf
    v_and_b32_dpp v52, v20, v3 row_newbcast:2 row_mask:0xf bank_mask:0xf
    v_and_b32_dpp v53, v20, v4 row_newbcast:2 row_mask:0xf bank_mask:0xf
    v_and_b32_dpp v54, v20, v3 row_newbcast:3 row_mask:0xf bank_mask:0xf
    v_and_b32_dpp v55, v20, v4 row_newbcast:3 row_mask:0xf bank_mask:0xf
    s_waitcnt vmcnt(10)
    v_smfmac_f32_16x16x64_bf16 v[36:39], v[48:51], v[160:167], v5
    v_and_b32_dpp v48, v20, v3 row_newbcast:4 row_mask:0xf bank_mask:0xf
    v_and_b32_dpp v49, v20, v4 row_newbcast:4 row_mask:0xf bank_mask:0xf
    v_and_b32_dpp v50, v20, v3 row_newbcast:5 row_mask:0xf bank_mask:0xf
    v_and_b32_dpp v51, v20, v4 row_newbcast:5 row_mask:0xf bank_mask:0xf
    s_waitcnt vmcnt(8)
    v_smfmac_f32_16x16x64_bf16 v[36:39], v[52:55], v[168:175], v5
    v_and_b32_dpp v52, v20, v3 row_newbcast:6 row_mask:0xf bank_mask:0xf
    v_and_b32_dpp v53, v20, v4 row_newbcast:6 row_mask:0xf bank_mask:0xf
    v_and_b32_dpp v54, v20, v3 row_newbcast:7 row_mask:0xf bank_mask:0xf
    v_and_b32_dpp v55, v20, v4 row_newbcast:7 row_mask:0xf bank_mask:0xf
    s_waitcnt vmcnt(6)
    v_smfmac_f32_16x16x64_bf16 v[36:39], v[48:51], v[176:183], v5
    v_and_b32_dpp v48, v20, v3 row_newbcast:8 row_mask:0xf bank_mask:0xf
    v_and_b32_dpp v49, v20, v4 row_newbcast:8 row_mask:0xf bank_mask:0xf
    v_and_b32_dpp v50, v20, v3 row_newbcast:9 row_mask:0xf bank_mask:0xf
    v_and_b32_dpp v51, v20, v4 row_newbcast:9 row_mask:0xf bank_mask:0xf
    s_waitcnt vmcnt(4)
    v_smfmac_f32_16x16x64_bf16 v[36:39], v[52:55], v[184:191], v5
    v_and_b32_dpp v52, v20, v3 row_newbcast:10 row_mask:0xf bank_mask:0xf
    v_and_b32_dpp v53, v20, v4 row_newbcast:10 row_mask:0xf bank_mask:0xf
    v_and_b32_dpp v54, v20, v3 row_newbcast:11 row_mask:0xf bank_mask:0xf
    v_and_b32_dpp v55, v20, v4 row_newbcast:11 row_mask:0xf bank_mask:0xf
    s_waitcnt vmcnt(2)
    v_smfmac_f32_16x16x64_bf16 v[36:39], v[48:51], v[192:199], v5
    s_waitcnt vmcnt(0)
    v_smfmac_f32_16x16x64_bf16 v[36:39], v[52:55], v[200:207], v5
    v_and_b32 v6, 7, v0
    v_lshrrev_b32 v7, 4, v0
    v_lshl_add_u32 v6, v7, 3, v6
    v_lshlrev_b32 v6, 3, v6
    v_bfe_u32 v7, v0, 3, 1
    v_lshlrev_b32 v7, 31, v7
    v_or_b32 v6, v6, v7
    s_mul_i32 s32, s30, 768
    s_add_u32 s32, s32, s35
    s_lshl_b32 s3, s24, 8
    s_add_u32 s32, s32, s3
    s_sub_u32 s32, s32, 1024
    v_mov_b32 v7, 0
    v_mov_b32 v9, 15
    v_add_f32_dpp v16, v38, v36 row_ror:8 row_mask:0xf bank_mask:0xf
    v_add_f32_dpp v17, v39, v37 row_ror:8 row_mask:0xf bank_mask:0xf
Lcf_loop:
    ds_read_b32 v8, v7 offset:4292
    s_waitcnt lgkmcnt(0)
    v_cmp_eq_u32 vcc, -1, v8
    s_cbranch_vccnz Lcf_retry
Lcf_ok:
    s_mul_i32 s66, s66, 1664525
    s_add_u32 s66, s66, 1013904223
    v_bfi_b32 v16, v9, s66, v16
    s_not_b32 s3, s66
    v_bfi_b32 v17, v9, s3, v17
    v_cmp_eq_u32 vcc, s38, v8
    s_cbranch_vccz L_qslow
    buffer_store_dwordx2 v[16:17], v6, s[12:15], s32 offen
    s_branch L_bprep
L_qslow:
    buffer_store_dwordx2 v[16:17], v6, s[12:15], s32 offen sc1
    s_branch L_bprep
L_aload:
    v_mov_b32 v6, 0
    s_cmp_eq_u32 s27, 0
    s_cbranch_scc1 L_adeep
    s_waitcnt vmcnt(3)
    buffer_load_dwordx4 v[84:87], v1, s[4:7], s40 offen offset:3328 nt
    s_waitcnt vmcnt(3)
    buffer_load_dwordx4 v[88:91], v1, s[4:7], s41 offen offset:0 nt
    s_waitcnt vmcnt(3)
    buffer_load_dwordx4 v[92:95], v1, s[4:7], s41 offen offset:128 nt
    s_waitcnt vmcnt(3)
    buffer_load_dwordx4 v[96:99], v1, s[4:7], s41 offen offset:256 nt
    s_waitcnt vmcnt(3)
    buffer_load_dwordx4 v[100:103], v1, s[4:7], s41 offen offset:3072 nt
    s_waitcnt vmcnt(3)
    buffer_load_dwordx4 v[104:107], v1, s[4:7], s41 offen offset:3200 nt
    s_waitcnt vmcnt(3)
    buffer_load_dwordx4 v[108:111], v1, s[4:7], s41 offen offset:3328 nt
    s_waitcnt vmcnt(3)
    buffer_load_dwordx4 v[112:115], v1, s[4:7], s42 offen offset:0 nt
    ds_write_b32 v6, v6 offset:4304
    s_waitcnt vmcnt(3)
    buffer_load_dwordx4 v[116:119], v1, s[4:7], s42 offen offset:128 nt
    s_waitcnt vmcnt(4)
    buffer_load_dwordx4 v[120:123], v1, s[4:7], s42 offen offset:256 nt
    s_waitcnt vmcnt(4)
    buffer_load_dwordx4 v[124:127], v1, s[4:7], s42 offen offset:3072 nt
    s_waitcnt vmcnt(4)
    buffer_load_dwordx4 v[128:131], v1, s[4:7], s42 offen offset:3200 nt
    s_waitcnt vmcnt(4)
    buffer_load_dwordx4 v[132:135], v1, s[4:7], s42 offen offset:3328 nt
    s_waitcnt vmcnt(4)
    buffer_load_dwordx4 v[136:139], v1, s[4:7], s43 offen offset:0 nt
    s_waitcnt vmcnt(4)
    buffer_load_dwordx4 v[140:143], v1, s[4:7], s43 offen offset:128 nt
    s_waitcnt vmcnt(4)
    buffer_load_dwordx4 v[144:147], v1, s[4:7], s43 offen offset:256 nt
    s_waitcnt vmcnt(4)
    buffer_load_dwordx4 v[148:151], v1, s[4:7], s43 offen offset:3072 nt
    s_waitcnt vmcnt(4)
    buffer_load_dwordx4 v[152:155], v1, s[4:7], s43 offen offset:3200 nt
    s_waitcnt vmcnt(4)
    buffer_load_dwordx4 v[156:159], v1, s[4:7], s43 offen offset:3328 nt
    s_waitcnt vmcnt(4)
    buffer_load_dwordx4 v[160:163], v2, s[8:11], s40 offen offset:0 nt
    s_waitcnt vmcnt(4)
    buffer_load_dwordx4 v[164:167], v2, s[8:11], s40 offen offset:1536 nt
    s_waitcnt vmcnt(4)
    buffer_load_dwordx4 v[168:171], v2, s[8:11], s40 offen offset:128 nt
    s_waitcnt vmcnt(4)
    buffer_load_dwordx4 v[172:175], v2, s[8:11], s40 offen offset:1664 nt
    s_waitcnt vmcnt(4)
    buffer_load_dwordx4 v[176:179], v2, s[8:11], s40 offen offset:256 nt
    s_waitcnt vmcnt(4)
    buffer_load_dwordx4 v[180:183], v2, s[8:11], s40 offen offset:1792 nt
    s_waitcnt vmcnt(4)
    buffer_load_dwordx4 v[184:187], v2, s[8:11], s41 offen offset:0 nt
    s_waitcnt vmcnt(4)
    buffer_load_dwordx4 v[188:191], v2, s[8:11], s41 offen offset:1536 nt
    s_waitcnt vmcnt(4)
    buffer_load_dwordx4 v[192:195], v2, s[8:11], s41 offen offset:128 nt
    s_waitcnt vmcnt(4)
    buffer_load_dwordx4 v[196:199], v2, s[8:11], s41 offen offset:1664 nt
    ds_write_b32 v6, v6 offset:4300
    s_waitcnt vmcnt(4)
    buffer_load_dwordx4 v[200:203], v2, s[8:11], s41 offen offset:256 nt
    s_waitcnt vmcnt(4)
    buffer_load_dwordx4 v[204:207], v2, s[8:11], s41 offen offset:1792 nt
    s_waitcnt vmcnt(4)
    buffer_load_dwordx4 v[208:211], v2, s[8:11], s42 offen offset:0 nt
    s_waitcnt vmcnt(4)
    buffer_load_dwordx4 v[212:215], v2, s[8:11], s42 offen offset:1536 nt
    s_waitcnt vmcnt(4)
    buffer_load_dwordx4 v[216:219], v2, s[8:11], s42 offen offset:128 nt
    s_waitcnt vmcnt(4)
    buffer_load_dwordx4 v[220:223], v2, s[8:11], s42 offen offset:1664 nt
    s_waitcnt vmcnt(4)
    buffer_load_dwordx4 v[224:227], v2, s[8:11], s42 offen offset:256 nt
    s_waitcnt vmcnt(4)
    buffer_load_dwordx4 v[228:231], v2, s[8:11], s42 offen offset:1792 nt
    s_waitcnt vmcnt(4)
    buffer_load_dwordx4 v[232:235], v2, s[8:11], s43 offen offset:0 nt
    s_waitcnt vmcnt(4)
    buffer_load_dwordx4 v[236:239], v2, s[8:11], s43 offen offset:1536 nt
    s_waitcnt vmcnt(4)
    buffer_load_dwordx4 v[240:243], v2, s[8:11], s43 offen offset:128 nt
    s_waitcnt vmcnt(4)
    buffer_load_dwordx4 v[244:247], v2, s[8:11], s43 offen offset:1664 nt
    s_waitcnt vmcnt(4)
    buffer_load_dwordx4 v[248:251], v2, s[8:11], s43 offen offset:256 nt
    s_waitcnt vmcnt(4)
    buffer_load_dwordx4 v[252:255], v2, s[8:11], s43 offen offset:1792 nt
    ds_write_b32 v13, v13 offset:4320
L_hop0:
    s_cbranch_execz L_hop1
L_acomp:
    s_mov_b32 s44, 0xcccccccc
    s_mov_b32 s45, 0xcccccccc
    s_mov_b32 s46, 0xaaaaaaaa
    s_mov_b32 s47, 0xaaaaaaaa
    v_and_b32 v8, 7, v0
    v_lshlrev_b32 v8, 4, v8
    v_mov_b32 v9, 0
Lqa_loop:
    ds_read_b32 v10, v9 offset:4288
    ds_read_b128 v[16:19], v8 offset:4352
    ds_read_b128 v[20:23], v8 offset:4480
    ds_read_b128 v[24:27], v8 offset:4608
    s_waitcnt lgkmcnt(0)
    v_cmp_eq_u32 vcc, -1, v10
    s_cbranch_vccnz Lqa_retry
Lqa_ok:
    v_readfirstlane_b32 s62, v10
    s_mul_i32 s66, s66, 1664525
    s_add_u32 s66, s66, 1013904223
    v_dot2_f32_bf16 v28, v64, v16, 0
    v_dot2_f32_bf16 v29, v76, v16, 0
    v_dot2_f32_bf16 v30, v88, v16, 0
    v_dot2_f32_bf16 v31, v100, v16, 0
    v_dot2_f32_bf16 v32, v112, v16, 0
    v_dot2_f32_bf16 v33, v124, v16, 0
    v_dot2_f32_bf16 v34, v136, v16, 0
    v_dot2_f32_bf16 v35, v148, v16, 0
    v_dot2c_f32_bf16 v28, v65, v17
    v_dot2c_f32_bf16 v28, v66, v18
    v_dot2c_f32_bf16 v28, v67, v19
    v_dot2c_f32_bf16 v28, v68, v20
    v_dot2c_f32_bf16 v28, v69, v21
    v_dot2c_f32_bf16 v28, v70, v22
    v_dot2c_f32_bf16 v28, v71, v23
    v_dot2c_f32_bf16 v28, v72, v24
    v_dot2c_f32_bf16 v28, v73, v25
    v_dot2c_f32_bf16 v28, v74, v26
    v_dot2c_f32_bf16 v28, v75, v27
    v_dot2c_f32_bf16 v29, v77, v17
    v_dot2c_f32_bf16 v29, v78, v18
    v_dot2c_f32_bf16 v29, v79, v19
    v_dot2c_f32_bf16 v29, v80, v20
    v_dot2c_f32_bf16 v29, v81, v21
    v_dot2c_f32_bf16 v29, v82, v22
    v_dot2c_f32_bf16 v29, v83, v23
    v_dot2c_f32_bf16 v29, v84, v24
    v_dot2c_f32_bf16 v29, v85, v25
L_hop1:
    s_cbranch_execz L_hop2
    v_dot2c_f32_bf16 v29, v86, v26
    v_dot2c_f32_bf16 v29, v87, v27
    v_dot2c_f32_bf16 v30, v89, v17
    v_dot2c_f32_bf16 v30, v90, v18
    v_dot2c_f32_bf16 v30, v91, v19
    v_dot2c_f32_bf16 v30, v92, v20
    v_dot2c_f32_bf16 v30, v93, v21
    v_dot2c_f32_bf16 v30, v94, v22
    v_dot2c_f32_bf16 v30, v95, v23
    v_dot2c_f32_bf16 v30, v96, v24
    v_dot2c_f32_bf16 v30, v97, v25
    v_dot2c_f32_bf16 v30, v98, v26
    v_dot2c_f32_bf16 v30, v99, v27
    v_dot2c_f32_bf16 v31, v101, v17
    v_dot2c_f32_bf16 v31, v102, v18
    v_dot2c_f32_bf16 v31, v103, v19
    v_dot2c_f32_bf16 v31, v104, v20
    v_dot2c_f32_bf16 v31, v105, v21
    v_dot2c_f32_bf16 v31, v106, v22
    v_dot2c_f32_bf16 v31, v107, v23
    v_dot2c_f32_bf16 v31, v108, v24
    v_dot2c_f32_bf16 v31, v109, v25
    v_dot2c_f32_bf16 v31, v110, v26
    v_dot2c_f32_bf16 v31, v111, v27
    v_dot2c_f32_bf16 v32, v113, v17
    v_dot2c_f32_bf16 v32, v114, v18
    v_dot2c_f32_bf16 v32, v115, v19
    v_dot2c_f32_bf16 v32, v116, v20
    v_dot2c_f32_bf16 v32, v117, v21
    v_dot2c_f32_bf16 v32, v118, v22
    v_dot2c_f32_bf16 v32, v119, v23
    v_dot2c_f32_bf16 v32, v120, v24
    v_dot2c_f32_bf16 v32, v121, v25
    v_dot2c_f32_bf16 v32, v122, v26
    v_dot2c_f32_bf16 v32, v123, v27
    v_dot2c_f32_bf16 v33, v125, v17
    v_dot2c_f32_bf16 v33, v126, v18
    v_dot2c_f32_bf16 v33, v127, v19
    v_dot2c_f32_bf16 v33, v128, v20
    v_dot2c_f32_bf16 v33, v129, v21
    v_dot2c_f32_bf16 v33, v130, v22
    v_dot2c_f32_bf16 v33, v131, v23
    v_dot2c_f32_bf16 v33, v132, v24
    v_dot2c_f32_bf16 v33, v133, v25
    v_dot2c_f32_bf16 v33, v134, v26
    v_dot2c_f32_bf16 v33, v135, v27
    v_dot2c_f32_bf16 v34, v137, v17
    v_dot2c_f32_bf16 v34, v138, v18
    v_dot2c_f32_bf16 v34, v139, v19
    v_dot2c_f32_bf16 v34, v140, v20
    v_dot2c_f32_bf16 v34, v141, v21
    v_dot2c_f32_bf16 v34, v142, v22
    v_dot2c_f32_bf16 v34, v143, v23
    v_dot2c_f32_bf16 v34, v144, v24
    v_dot2c_f32_bf16 v34, v145, v25
    v_dot2c_f32_bf16 v34, v146, v26
    v_dot2c_f32_bf16 v34, v147, v27
    v_dot2c_f32_bf16 v35, v149, v17
    v_dot2c_f32_bf16 v35, v150, v18
    v_dot2c_f32_bf16 v35, v151, v19
    v_dot2c_f32_bf16 v35, v152, v20
    v_dot2c_f32_bf16 v35, v153, v21
    v_dot2c_f32_bf16 v35, v154, v22
L_hop2:
    s_cbranch_execz L_hop3
    v_dot2c_f32_bf16 v35, v155, v23
    v_dot2c_f32_bf16 v35, v156, v24
    v_dot2c_f32_bf16 v35, v157, v25
    v_dot2c_f32_bf16 v35, v158, v26
    v_dot2c_f32_bf16 v35, v159, v27
    v_add_f32_dpp v28, v28, v28 row_half_mirror row_mask:0xf bank_mask:0x5
    v_add_f32_dpp v29, v29, v29 row_half_mirror row_mask:0xf bank_mask:0x5
    v_add_f32_dpp v30, v30, v30 row_half_mirror row_mask:0xf bank_mask:0x5
    v_add_f32_dpp v31, v31, v31 row_half_mirror row_mask:0xf bank_mask:0x5
    v_add_f32_dpp v28, v32, v32 row_half_mirror row_mask:0xf bank_mask:0xa
    v_add_f32_dpp v29, v33, v33 row_half_mirror row_mask:0xf bank_mask:0xa
    v_add_f32_dpp v30, v34, v34 row_half_mirror row_mask:0xf bank_mask:0xa
    v_add_f32_dpp v31, v35, v35 row_half_mirror row_mask:0xf bank_mask:0xa
    v_add_f32_dpp v28, v28, v28 quad_perm:[2,3,0,1] row_mask:0xf bank_mask:0xf
    v_add_f32_dpp v29, v29, v29 quad_perm:[2,3,0,1] row_mask:0xf bank_mask:0xf
    v_add_f32_dpp v30, v30, v30 quad_perm:[2,3,0,1] row_mask:0xf bank_mask:0xf
    v_add_f32_dpp v31, v31, v31 quad_perm:[2,3,0,1] row_mask:0xf bank_mask:0xf
    v_cndmask_b32 v28, v28, v30, s[44:45]
    v_cndmask_b32 v29, v29, v31, s[44:45]
    s_nop 0
    v_add_f32_dpp v28, v28, v28 quad_perm:[1,0,3,2] row_mask:0xf bank_mask:0xf
    v_add_f32_dpp v29, v29, v29 quad_perm:[1,0,3,2] row_mask:0xf bank_mask:0xf
    v_cndmask_b32 v28, v28, v29, s[46:47]
    v_cvt_pk_bf16_f32 v28, 0, v28
    v_mul_f32 v28, 0x3d93cd3a, v28
    v_cvt_pk_bf16_f32 v28, 0, v28
    v_mov_b32 v10, v28
    s_nop 1
    v_max_f32_dpp v10, v10, v10 quad_perm:[1,0,3,2] row_mask:0xf bank_mask:0xf
    s_nop 1
    v_max_f32_dpp v10, v10, v10 quad_perm:[2,3,0,1] row_mask:0xf bank_mask:0xf
    s_nop 1
    v_max_f32_dpp v10, v10, v10 row_half_mirror row_mask:0xf bank_mask:0xf
    s_nop 1
    v_max_f32_dpp v10, v10, v10 row_mirror row_mask:0xf bank_mask:0xf
    s_nop 1
    v_max_f32_dpp v10, v10, v10 row_bcast:15 row_mask:0xa bank_mask:0xf
L_hop3:
    s_cbranch_execz L_hop4
    s_nop 0
    v_max_f32_dpp v10, v10, v10 row_bcast:31 row_mask:0xc bank_mask:0xf
    s_nop 0
    v_readlane_b32 s33, v10, 63
    v_mov_b32 v36, 0
    v_mov_b32 v37, 0
    v_mov_b32 v38, 0
    v_mov_b32 v39, 0
    v_mov_b32 v40, 0
    v_mov_b32 v41, 0
    v_mov_b32 v42, 0
    v_mov_b32 v43, 0
    v_mov_b32 v44, 0
    v_mov_b32 v45, 0
    v_mov_b32 v46, 0
    v_mov_b32 v47, 0
    v_subrev_f32 v8, s33, v28
    v_mul_f32 v8, 0x3fb8aa3b, v8
    v_exp_f32 v8, v8
    s_lshl_b32 s32, s24, 10
    v_lshl_add_u32 v7, v0, 4, s32
    v_mov_b32_dpp v9, v8 row_ror:8 row_mask:0xf bank_mask:0xf
    v_add_f32_dpp v28, v8, v8 quad_perm:[1,0,3,2] row_mask:0xf bank_mask:0xf
    v_cvt_pk_bf16_f32 v9, v8, v9
    s_nop 0
    v_add_f32_dpp v28, v28, v28 quad_perm:[2,3,0,1] row_mask:0xf bank_mask:0xf
    v_and_b32_dpp v48, v9, v3 row_newbcast:0 row_mask:0xf bank_mask:0xf
    v_and_b32_dpp v49, v9, v4 row_newbcast:0 row_mask:0xf bank_mask:0xf
    v_and_b32_dpp v50, v9, v3 row_newbcast:1 row_mask:0xf bank_mask:0xf
    v_and_b32_dpp v51, v9, v4 row_newbcast:1 row_mask:0xf bank_mask:0xf
    v_and_b32_dpp v52, v9, v3 row_newbcast:2 row_mask:0xf bank_mask:0xf
    v_and_b32_dpp v53, v9, v4 row_newbcast:2 row_mask:0xf bank_mask:0xf
    v_and_b32_dpp v54, v9, v3 row_newbcast:3 row_mask:0xf bank_mask:0xf
    v_and_b32_dpp v55, v9, v4 row_newbcast:3 row_mask:0xf bank_mask:0xf
    v_and_b32_dpp v56, v9, v3 row_newbcast:4 row_mask:0xf bank_mask:0xf
    v_and_b32_dpp v57, v9, v4 row_newbcast:4 row_mask:0xf bank_mask:0xf
    v_and_b32_dpp v58, v9, v3 row_newbcast:5 row_mask:0xf bank_mask:0xf
    v_and_b32_dpp v59, v9, v4 row_newbcast:5 row_mask:0xf bank_mask:0xf
    v_and_b32_dpp v60, v9, v3 row_newbcast:6 row_mask:0xf bank_mask:0xf
    v_and_b32_dpp v61, v9, v4 row_newbcast:6 row_mask:0xf bank_mask:0xf
L_hop4:
    s_cbranch_execz L_hop5
    v_and_b32_dpp v62, v9, v3 row_newbcast:7 row_mask:0xf bank_mask:0xf
    v_and_b32_dpp v63, v9, v4 row_newbcast:7 row_mask:0xf bank_mask:0xf
    s_waitcnt vmcnt(18)
    v_smfmac_f32_16x16x64_bf16 v[36:39], v[48:51], v[160:167], v5
    v_smfmac_f32_16x16x64_bf16 v[40:43], v[48:51], v[168:175], v5
    v_smfmac_f32_16x16x64_bf16 v[44:47], v[48:51], v[176:183], v5
    s_waitcnt vmcnt(12)
    v_smfmac_f32_16x16x64_bf16 v[36:39], v[52:55], v[184:191], v5
    v_smfmac_f32_16x16x64_bf16 v[40:43], v[52:55], v[192:199], v5
    v_smfmac_f32_16x16x64_bf16 v[44:47], v[52:55], v[200:207], v5
    s_waitcnt vmcnt(6)
    v_smfmac_f32_16x16x64_bf16 v[36:39], v[56:59], v[208:215], v5
    v_smfmac_f32_16x16x64_bf16 v[40:43], v[56:59], v[216:223], v5
    v_smfmac_f32_16x16x64_bf16 v[44:47], v[56:59], v[224:231], v5
    s_waitcnt vmcnt(0)
    v_smfmac_f32_16x16x64_bf16 v[36:39], v[60:63], v[232:239], v5
    v_smfmac_f32_16x16x64_bf16 v[40:43], v[60:63], v[240:247], v5
    v_smfmac_f32_16x16x64_bf16 v[44:47], v[60:63], v[248:255], v5
    v_mov_b32 v10, s33
    v_add_f32_dpp v11, v28, v28 row_half_mirror row_mask:0xf bank_mask:0xf
    s_nop 1
    v_add_f32_dpp v11, v11, v11 row_mirror row_mask:0xf bank_mask:0xf
    s_nop 1
    v_add_f32_dpp v11, v11, v11 row_bcast:15 row_mask:0xa bank_mask:0xf
    s_nop 1
    v_add_f32_dpp v11, v11, v11 row_bcast:31 row_mask:0xc bank_mask:0xf
    v_add_f32_dpp v48, v38, v36 row_ror:8 row_mask:0xf bank_mask:0xf
    v_add_f32_dpp v49, v39, v37 row_ror:8 row_mask:0xf bank_mask:0xf
L_hop5:
    s_cbranch_execz L_hop6
    v_add_f32_dpp v48, v40, v42 row_ror:8 row_mask:0xf bank_mask:0xc
    v_add_f32_dpp v49, v41, v43 row_ror:8 row_mask:0xf bank_mask:0xc
    v_add_f32_dpp v50, v46, v44 row_ror:8 row_mask:0xf bank_mask:0xf
    v_add_f32_dpp v51, v47, v45 row_ror:8 row_mask:0xf bank_mask:0xf
    ds_write_b128 v7, v[48:51] offset:8192
    s_mov_b32 exec_lo, 0
    s_mov_b32 exec_hi, 0x80000000
    ds_write_b64 v13, v[10:11] offset:4224
    s_mov_b64 exec, -1
    s_cmp_lt_u32 s28, 24
    s_cbranch_scc1 L_fin
    s_branch L_hc
L_adeep:
    s_cmp_lt_u32 s28, 24
    s_cbranch_scc1 L_adeepf
    s_waitcnt vmcnt(7)
    buffer_load_dwordx4 v[84:87], v1, s[4:7], s40 offen offset:3328 nt
    s_waitcnt vmcnt(7)
    buffer_load_dwordx4 v[88:91], v1, s[4:7], s41 offen offset:0 nt
    s_waitcnt vmcnt(7)
    buffer_load_dwordx4 v[92:95], v1, s[4:7], s41 offen offset:128 nt
    s_waitcnt vmcnt(7)
    buffer_load_dwordx4 v[96:99], v1, s[4:7], s41 offen offset:256 nt
    s_waitcnt vmcnt(7)
    buffer_load_dwordx4 v[100:103], v1, s[4:7], s41 offen offset:3072 nt
    s_waitcnt vmcnt(7)
    buffer_load_dwordx4 v[104:107], v1, s[4:7], s41 offen offset:3200 nt
    s_waitcnt vmcnt(7)
    buffer_load_dwordx4 v[108:111], v1, s[4:7], s41 offen offset:3328 nt
    s_waitcnt vmcnt(7)
    buffer_load_dwordx4 v[112:115], v1, s[4:7], s42 offen offset:0 nt
    s_waitcnt vmcnt(7)
    buffer_load_dwordx4 v[116:119], v1, s[4:7], s42 offen offset:128 nt
    s_waitcnt vmcnt(7)
    buffer_load_dwordx4 v[120:123], v1, s[4:7], s42 offen offset:256 nt
    s_branch L_adeep2
L_hop6:
    s_cbranch_execz L_hop7
L_adeepf:
    s_waitcnt vmcnt(2)
    buffer_load_dwordx4 v[84:87], v1, s[4:7], s40 offen offset:3328 nt
    s_waitcnt vmcnt(2)
    buffer_load_dwordx4 v[88:91], v1, s[4:7], s41 offen offset:0 nt
    s_waitcnt vmcnt(2)
    buffer_load_dwordx4 v[92:95], v1, s[4:7], s41 offen offset:128 nt
    s_waitcnt vmcnt(2)
    buffer_load_dwordx4 v[96:99], v1, s[4:7], s41 offen offset:256 nt
    s_waitcnt vmcnt(2)
    buffer_load_dwordx4 v[100:103], v1, s[4:7], s41 offen offset:3072 nt
    s_waitcnt vmcnt(2)
    buffer_load_dwordx4 v[104:107], v1, s[4:7], s41 offen offset:3200 nt
    s_waitcnt vmcnt(2)
    buffer_load_dwordx4 v[108:111], v1, s[4:7], s41 offen offset:3328 nt
    s_waitcnt vmcnt(2)
    buffer_load_dwordx4 v[112:115], v1, s[4:7], s42 offen offset:0 nt
    s_waitcnt vmcnt(2)
    buffer_load_dwordx4 v[116:119], v1, s[4:7], s42 offen offset:128 nt
    s_waitcnt vmcnt(2)
    buffer_load_dwordx4 v[120:123], v1, s[4:7], s42 offen offset:256 nt
L_adeep2:
    s_waitcnt vmcnt(7)
    buffer_load_dwordx4 v[124:127], v1, s[4:7], s42 offen offset:3072 nt
    s_waitcnt vmcnt(7)
    buffer_load_dwordx4 v[128:131], v1, s[4:7], s42 offen offset:3200 nt
    s_waitcnt vmcnt(7)
    buffer_load_dwordx4 v[132:135], v1, s[4:7], s42 offen offset:3328 nt
    s_waitcnt vmcnt(7)
    buffer_load_dwordx4 v[136:139], v1, s[4:7], s43 offen offset:0 nt
    s_waitcnt vmcnt(7)
    buffer_load_dwordx4 v[140:143], v1, s[4:7], s43 offen offset:128 nt
    s_waitcnt vmcnt(7)
    buffer_load_dwordx4 v[144:147], v1, s[4:7], s43 offen offset:256 nt
    s_waitcnt vmcnt(7)
    buffer_load_dwordx4 v[148:151], v1, s[4:7], s43 offen offset:3072 nt
    ds_write_b32 v6, v6 offset:4304
    s_waitcnt vmcnt(7)
    buffer_load_dwordx4 v[152:155], v1, s[4:7], s43 offen offset:3200 nt
    s_waitcnt vmcnt(7)
    buffer_load_dwordx4 v[156:159], v1, s[4:7], s43 offen offset:3328 nt
    s_waitcnt vmcnt(7)
    buffer_load_dwordx4 v[160:163], v2, s[8:11], s40 offen offset:0 nt
L_hop7:
    s_cbranch_execz L_hop8
    s_waitcnt vmcnt(7)
    buffer_load_dwordx4 v[164:167], v2, s[8:11], s40 offen offset:1536 nt
    s_waitcnt vmcnt(7)
    buffer_load_dwordx4 v[168:171], v2, s[8:11], s40 offen offset:128 nt
    s_waitcnt vmcnt(7)
    buffer_load_dwordx4 v[172:175], v2, s[8:11], s40 offen offset:1664 nt
    s_waitcnt vmcnt(7)
    buffer_load_dwordx4 v[176:179], v2, s[8:11], s40 offen offset:256 nt
    s_waitcnt vmcnt(7)
    buffer_load_dwordx4 v[180:183], v2, s[8:11], s40 offen offset:1792 nt
    s_waitcnt vmcnt(7)
    buffer_load_dwordx4 v[184:187], v2, s[8:11], s41 offen offset:0 nt
    s_waitcnt vmcnt(7)
    buffer_load_dwordx4 v[188:191], v2, s[8:11], s41 offen offset:1536 nt
    s_waitcnt vmcnt(7)
    buffer_load_dwordx4 v[192:195], v2, s[8:11], s41 offen offset:128 nt
    s_waitcnt vmcnt(7)
    buffer_load_dwordx4 v[196:199], v2, s[8:11], s41 offen offset:1664 nt
    ds_write_b32 v6, v6 offset:4300
    s_waitcnt vmcnt(7)
    buffer_load_dwordx4 v[200:203], v2, s[8:11], s41 offen offset:256 nt
    s_waitcnt vmcnt(7)
    buffer_load_dwordx4 v[204:207], v2, s[8:11], s41 offen offset:1792 nt
    s_waitcnt vmcnt(7)
    buffer_load_dwordx4 v[208:211], v2, s[8:11], s42 offen offset:0 nt
    s_waitcnt vmcnt(7)
    buffer_load_dwordx4 v[212:215], v2, s[8:11], s42 offen offset:1536 nt
    s_waitcnt vmcnt(7)
    buffer_load_dwordx4 v[216:219], v2, s[8:11], s42 offen offset:128 nt
    s_waitcnt vmcnt(7)
    buffer_load_dwordx4 v[220:223], v2, s[8:11], s42 offen offset:1664 nt
    s_waitcnt vmcnt(7)
    buffer_load_dwordx4 v[224:227], v2, s[8:11], s42 offen offset:256 nt
    s_waitcnt vmcnt(7)
    buffer_load_dwordx4 v[228:231], v2, s[8:11], s42 offen offset:1792 nt
    s_waitcnt vmcnt(7)
    buffer_load_dwordx4 v[232:235], v2, s[8:11], s43 offen offset:0 nt
    s_waitcnt vmcnt(7)
    buffer_load_dwordx4 v[236:239], v2, s[8:11], s43 offen offset:1536 nt
    s_waitcnt vmcnt(7)
    buffer_load_dwordx4 v[240:243], v2, s[8:11], s43 offen offset:128 nt
L_hop8:
    s_cbranch_execz L_hop9
    s_waitcnt vmcnt(7)
    buffer_load_dwordx4 v[244:247], v2, s[8:11], s43 offen offset:1664 nt
    s_waitcnt vmcnt(7)
    buffer_load_dwordx4 v[248:251], v2, s[8:11], s43 offen offset:256 nt
    s_waitcnt vmcnt(7)
    buffer_load_dwordx4 v[252:255], v2, s[8:11], s43 offen offset:1792 nt
    ds_write_b32 v13, v13 offset:4320
    s_branch L_acomp
L_w1:
    s_load_dwordx2 s[16:17], s[0:1], 48
    s_mov_b32 s18, 1966080
    s_sub_u32 s3, s24, 4
    s_mul_i32 s51, s3, 491520
    s_lshl_b32 s32, s28, 7
    s_add_u32 s51, s51, s32
    s_add_u32 s52, s51, 245760
    v_lshrrev_b32 v8, 5, v0
    v_mul_u32_u24 v8, 40, v8
    v_bfe_u32 v9, v0, 3, 2
    v_add_u32 v8, v8, v9
    v_mul_u32_u24 v8, 3072, v8
    v_and_b32 v9, 7, v0
    v_lshl_add_u32 v28, v9, 4, v8
    s_waitcnt lgkmcnt(0)
    s_waitcnt vmcnt(4)
    buffer_load_dwordx4 v[112:115], v28, s[16:19], s51 offen nt
    s_add_u32 s51, s51, 12288
    s_waitcnt vmcnt(4)
    buffer_load_dwordx4 v[116:119], v28, s[16:19], s52 offen nt
    s_add_u32 s52, s52, 12288
    s_waitcnt vmcnt(4)
    buffer_load_dwordx4 v[120:123], v28, s[16:19], s51 offen nt
    s_add_u32 s51, s51, 12288
    s_waitcnt vmcnt(4)
    buffer_load_dwordx4 v[124:127], v28, s[16:19], s52 offen nt
    s_add_u32 s52, s52, 12288
    s_waitcnt vmcnt(4)
    buffer_load_dwordx4 v[128:131], v28, s[16:19], s51 offen nt
    s_add_u32 s51, s51, 12288
L_hop9:
    s_cbranch_execz L_hop10
    s_waitcnt vmcnt(4)
    buffer_load_dwordx4 v[132:135], v28, s[16:19], s52 offen nt
    s_add_u32 s52, s52, 12288
    s_waitcnt vmcnt(4)
    buffer_load_dwordx4 v[136:139], v28, s[16:19], s51 offen nt
    s_add_u32 s51, s51, 12288
    s_waitcnt vmcnt(4)
    buffer_load_dwordx4 v[140:143], v28, s[16:19], s52 offen nt
    s_add_u32 s52, s52, 12288
    s_waitcnt vmcnt(4)
    buffer_load_dwordx4 v[144:147], v28, s[16:19], s51 offen nt
    s_add_u32 s51, s51, 12288
    s_waitcnt vmcnt(4)
    buffer_load_dwordx4 v[148:151], v28, s[16:19], s52 offen nt
    s_add_u32 s52, s52, 12288
    s_waitcnt vmcnt(4)
    buffer_load_dwordx4 v[152:155], v28, s[16:19], s51 offen nt
    s_waitcnt vmcnt(4)
    buffer_load_dwordx4 v[156:159], v28, s[16:19], s52 offen nt
    s_waitcnt vmcnt(0)
    s_cmp_eq_u32 s24, 7
    s_cbranch_scc0 L_bprep
L_w7b:
    s_and_b32 s32, s25, 28
    v_bfe_u32 v15, v0, 1, 2
    v_add_u32 v15, s32, v15
    v_mul_u32_u24 v15, 5632, v15
    v_and_b32 v12, 1, v0
    v_lshl_add_u32 v15, v12, 4, v15
    s_mov_b32 s32, 529664
    v_mov_b32 v12, 0x80000000
    v_cmp_gt_u32 vcc, 48, v0
L_hop10:
    s_cbranch_execz L_hop11
    s_nop 0
    v_cndmask_b32 v6, v12, v6, vcc
    v_cndmask_b32 v44, 0, 15, vcc
    v_lshrrev_b32 v12, 4, v0
    v_lshlrev_b32 v12, 7, v12
    v_and_b32 v8, 3, v0
    v_lshl_add_u32 v12, v8, 5, v12
    v_bfe_u32 v8, v0, 2, 2
    v_lshl_add_u32 v12, v8, 2, v12
    v_add_u32 v12, 4352, v12
    s_add_u32 s48, s35, 3072
    s_mov_b32 s34, 3
Lg00_loop:
    ds_read_b32 v8, v7 offset:4304
    s_waitcnt lgkmcnt(0)
    v_cmp_eq_u32 vcc, -1, v8
    s_cbranch_vccnz Lg00_retry
Lg00_ok:
L_fwait:
    buffer_load_dwordx4 v[8:11], v15, s[12:15], s32 offen sc1
    s_waitcnt vmcnt(0)
    v_bitop3_b32 v8, v8, v9, v14 bitop3:0x7e
    v_bitop3_b32 v10, v10, v11, v14 bitop3:0x7e
    v_or_b32 v8, v8, v10
    v_cmp_lt_u32 vcc, 15, v8
    s_cbranch_vccnz Lfl_retry
Lfl_ok:
    v_cmp_ne_u32 vcc, 0, v8
    s_cmp_eq_u64 vcc, 0
    s_cselect_b32 s32, 1, 0
    v_mov_b32 v14, s32
    ds_write_b32 v7, v14 offset:4292
Lg0_loop:
    ds_read_b32 v8, v7 offset:4300
    s_waitcnt lgkmcnt(0)
    v_cmp_eq_u32 vcc, -1, v8
    s_cbranch_vccnz Lg0_retry
Lg0_ok:
L_qpoll:
    buffer_load_dwordx4 v[16:19], v6, s[12:15], s35 offen offset:0 sc1
    buffer_load_dwordx4 v[20:23], v6, s[12:15], s35 offen offset:768 sc1
    buffer_load_dwordx4 v[24:27], v6, s[12:15], s35 offen offset:1536 sc1
    buffer_load_dwordx4 v[28:31], v6, s[12:15], s35 offen offset:2304 sc1
    buffer_load_dwordx4 v[32:35], v6, s[12:15], s48 offen offset:0 sc1
    buffer_load_dwordx4 v[36:39], v6, s[12:15], s48 offen offset:768 sc1
    buffer_load_dwordx4 v[40:43], v6, s[12:15], s48 offen offset:1536 sc1
L_hop11:
    s_cbranch_execz L_hop12
    s_waitcnt vmcnt(0)
    v_bitop3_b32 v48, v16, v17, s66 bitop3:0xdb
    v_bitop3_b32 v49, v18, v19, s66 bitop3:0xdb
    v_bitop3_b32 v50, v20, v21, s66 bitop3:0xdb
    v_bitop3_b32 v51, v22, v23, s66 bitop3:0xdb
    v_bitop3_b32 v52, v24, v25, s66 bitop3:0xdb
    v_bitop3_b32 v53, v26, v27, s66 bitop3:0xdb
    v_bitop3_b32 v54, v28, v29, s66 bitop3:0xdb
    v_bitop3_b32 v55, v30, v31, s66 bitop3:0xdb
    v_bitop3_b32 v56, v32, v33, s66 bitop3:0xdb
    v_bitop3_b32 v57, v34, v35, s66 bitop3:0xdb
    v_bitop3_b32 v58, v36, v37, s66 bitop3:0xdb
    v_bitop3_b32 v59, v38, v39, s66 bitop3:0xdb
    v_bitop3_b32 v60, v40, v41, s66 bitop3:0xdb
    v_bitop3_b32 v61, v42, v43, s66 bitop3:0xdb
    v_or3_b32 v48, v48, v49, v50
    v_or3_b32 v48, v48, v51, v52
    v_or3_b32 v48, v48, v53, v54
    v_or3_b32 v48, v48, v55, v56
    v_or3_b32 v48, v48, v57, v58
    v_or3_b32 v48, v48, v59, v60
    v_bitop3_b32 v48, v48, v44, v61 bitop3:0xc8
    v_cmp_ne_u32 vcc, 0, v48
    v_and_b32 v16, -16, v16
    v_and_b32 v17, -16, v17
    v_and_b32 v18, -16, v18
    v_and_b32 v19, -16, v19
    v_and_b32 v20, -16, v20
    v_and_b32 v21, -16, v21
    v_and_b32 v22, -16, v22
    v_and_b32 v23, -16, v23
    v_and_b32 v24, -16, v24
    v_and_b32 v25, -16, v25
    v_and_b32 v26, -16, v26
    v_and_b32 v27, -16, v27
    v_and_b32 v28, -16, v28
    v_and_b32 v29, -16, v29
    v_and_b32 v30, -16, v30
    v_and_b32 v31, -16, v31
    v_and_b32 v32, -16, v32
    v_and_b32 v33, -16, v33
    v_and_b32 v34, -16, v34
L_hop12:
    s_cbranch_execz L_hop13
    v_and_b32 v35, -16, v35
    v_and_b32 v36, -16, v36
    v_and_b32 v37, -16, v37
    v_and_b32 v38, -16, v38
    v_and_b32 v39, -16, v39
    v_and_b32 v40, -16, v40
    v_and_b32 v41, -16, v41
    v_and_b32 v42, -16, v42
    v_and_b32 v43, -16, v43
    s_cbranch_vccnz Lqp_retry
Lqp_ok:
    v_pk_add_f32 v[16:17], v[16:17], v[20:21]
    v_pk_add_f32 v[18:19], v[18:19], v[22:23]
    v_pk_add_f32 v[16:17], v[16:17], v[24:25]
    v_pk_add_f32 v[18:19], v[18:19], v[26:27]
    v_pk_add_f32 v[16:17], v[16:17], v[28:29]
    v_pk_add_f32 v[18:19], v[18:19], v[30:31]
    v_pk_add_f32 v[16:17], v[16:17], v[32:33]
    v_pk_add_f32 v[18:19], v[18:19], v[34:35]
    v_pk_add_f32 v[16:17], v[16:17], v[36:37]
    v_pk_add_f32 v[18:19], v[18:19], v[38:39]
    v_pk_add_f32 v[16:17], v[16:17], v[40:41]
    v_pk_add_f32 v[18:19], v[18:19], v[42:43]
    v_cvt_pk_bf16_f32 v16, v16, v17
    v_cvt_pk_bf16_f32 v17, v18, v19
    ds_write2_b32 v12, v16, v17 offset0:0 offset1:4
    ds_write_b32 v7, v14 offset:4288
L_bprep:
    s_setprio 0
    s_cmp_eq_u32 s24, 6
    s_cbranch_scc1 L_touch
L_hopend:
    s_mov_b64 exec, -1
    s_load_dwordx2 s[16:17], s[0:1], 32
    s_lshl_b32 s32, s26, 2
    s_lshr_b32 s34, 0x34355444, s32
    s_and_b32 s34, s34, 15
    s_cmp_eq_u32 s27, 0
    s_cselect_b32 s34, s34, 4
    s_cselect_b32 s37, 1, 0
    s_cmp_lt_u32 s28, 24
    s_cselect_b32 s37, 1, s37
    s_mov_b32 s39, s43
    s_lshl_b32 s32, s27, 2
    s_lshr_b32 s46, 0x11221111, s32
    s_and_b32 s46, s46, 15
    s_add_u32 s64, s64, 4
L_hop13:
    s_cbranch_execz L_hop14
    s_and_b32 s32, s64, 31
    s_mul_i32 s32, s32, 6144
    s_add_u32 s40, s65, s32
    s_add_u32 s64, s64, 4
    s_and_b32 s32, s64, 31
    s_mul_i32 s32, s32, 6144
    s_add_u32 s41, s65, s32
    s_add_u32 s64, s64, 4
    s_and_b32 s32, s64, 31
    s_mul_i32 s32, s32, 6144
    s_add_u32 s42, s65, s32
    s_lshl_b32 s32, s26, 2
    s_lshr_b32 s3, 0x75000, s32
    s_and_b32 s3, s3, 7
    s_add_u32 s65, s36, s3
    s_mul_i32 s65, s65, 196608
    s_sub_u32 s3, s3, s26
    s_add_u32 s32, s64, s3
    s_and_b32 s32, s32, 31
    s_mul_i32 s32, s32, 6144
    s_add_u32 s43, s65, s32
    s_lshl_b32 s32, s26, 2
    s_lshr_b32 s3, 0x0, s32
    s_and_b32 s3, s3, 7
    s_add_u32 s65, s36, s3
    s_mul_i32 s65, s65, 196608
    s_sub_u32 s3, s3, s26
    s_add_u32 s32, s64, s3
    s_and_b32 s32, s32, 31
    s_mul_i32 s32, s32, 6144
    s_add_u32 s44, s65, s32
    s_lshl_b32 s32, s26, 2
    s_lshr_b32 s3, 0x0, s32
    s_and_b32 s3, s3, 7
    s_add_u32 s65, s36, s3
    s_mul_i32 s65, s65, 196608
    s_sub_u32 s3, s3, s26
    s_add_u32 s32, s64, s3
    s_and_b32 s32, s32, 31
    s_mul_i32 s32, s32, 6144
    s_add_u32 s45, s65, s32
    s_mov_b32 s33, 0xff800000
    s_not_b32 s47, s66
    s_mov_b32 s58, 0
    s_mov_b32 s59, 0x10000
    s_sub_u32 s54, s24, 4
    s_lshl_b32 s53, s25, 3
    s_add_u32 s53, s53, s26
    s_lshl_b32 s53, s53, 10
    s_mul_i32 s30, s25, 5
    s_add_u32 s30, s30, s26
L_hop14:
    s_cbranch_execz L_hop15
    s_sub_u32 s30, s30, 3
    s_sub_u32 s32, s25, 4
    s_cmp_lt_u32 s32, 12
    s_cselect_b32 s32, s32, 200
    s_sub_u32 s3, 2, s26
    s_mul_i32 s3, s3, 12
    s_add_u32 s32, s32, s3
    s_cmp_lt_u32 s32, 20
    s_cselect_b32 s32, s32, 200
    s_cmp_ge_u32 s26, 3
    s_cselect_b32 s30, s30, s32
    s_cmp_eq_u32 s27, 0
    s_cselect_b32 s30, 200, s30
    s_cmp_lt_u32 s30, 160
    s_cselect_b32 s18, 7864320, 0
    s_mul_i32 s29, s30, 205
    s_lshr_b32 s29, s29, 11
    s_mul_i32 s32, s29, 10
    s_sub_u32 s30, s30, s32
    s_cmp_eq_u32 s27, 0
    s_cselect_b32 s32, 3, 0
    s_xor_b32 s63, s26, s32
    s_lshr_b32 s32, s54, 1
    s_xor_b32 s32, s32, s25
    s_and_b32 s32, s32, 1
    s_or_b32 s63, s63, s32
    s_lshr_b32 s32, s25, 1
    s_cmp_eq_u32 s63, 0
    s_cselect_b32 s29, s32, s29
    s_mul_i32 s49, s29, 1536
    s_mul_i32 s32, s54, 384
    s_add_u32 s49, s49, s32
    s_add_u32 s49, s49, 262144
    s_mul_i32 s51, s29, 491520
    s_mul_i32 s3, s54, 122880
    s_add_u32 s51, s51, s3
    s_lshl_b32 s3, s30, 7
    s_add_u32 s51, s51, s3
    s_add_u32 s52, s51, 61440
    s_lshr_b32 s32, s54, 1
    s_lshl_b32 s3, s29, 1
    s_add_u32 s32, s32, s3
    s_lshl_b32 s48, s32, 13
    s_and_b32 s32, s29, 1
    s_mul_i32 s50, s32, 2560
    s_lshl_b32 s3, s30, 8
    s_add_u32 s50, s50, s3
    s_lshr_b32 s3, s29, 1
    s_lshl_b32 s3, s3, 14
    s_add_u32 s50, s50, s3
L_hop15:
    s_cbranch_execz L_hop16
    s_add_u32 s50, s50, 1048576
    v_lshrrev_b32 v14, 5, v0
    v_mul_u32_u24 v14, 24, v14
    v_bfe_u32 v15, v0, 3, 2
    v_add_u32 v14, v14, v15
    v_mul_u32_u24 v14, 1280, v14
    v_and_b32 v15, 7, v0
    v_lshl_add_u32 v29, v15, 4, v14
    v_and_b32 v7, 7, v0
    v_lshrrev_b32 v8, 4, v0
    v_and_b32 v9, 15, v0
    v_bfe_u32 v11, v0, 3, 1
    v_lshlrev_b32 v14, 5, v7
    v_lshl_add_u32 v14, v8, 3, v14
    s_lshl_b32 s32, s54, 8
    s_add_u32 s32, s32, 3072
    s_sub_u32 s3, 7680, s32
    v_mul_u32_u24 v15, s3, v11
    v_add3_u32 v250, v14, v15, s32
    s_mul_i32 s32, s54, 768
    s_add_u32 s32, s32, 512
    s_sub_u32 s3, 7680, s32
    v_mul_u32_u24 v15, s3, v11
    v_add3_u32 v243, v14, v15, s32
    v_lshlrev_b32 v6, 5, v9
    v_lshl_add_u32 v6, v8, 3, v6
    s_sub_u32 s32, s32, 512
    v_add_u32 v6, s32, v6
    v_lshlrev_b32 v11, 12, v11
    v_and_b32 v10, 3, v0
    v_lshl_add_u32 v249, v10, 10, v11
    v_mul_u32_u24 v10, 96, v8
    v_lshl_add_u32 v10, v7, 4, v10
    v_mov_b32 v253, v10
    s_and_b32 s32, s24, 1
    s_mul_i32 s32, s32, 384
    v_add3_u32 v10, v10, v11, s32
    v_mov_b32 v11, 0x80000000
    v_mov_b32 v246, s66
    v_cmp_gt_u32 vcc, 6, v7
L_hop16:
    s_cbranch_execz L_hop17
    s_nop 0
    v_cndmask_b32 v248, v11, v10, vcc
    v_cndmask_b32 v253, v11, v253, vcc
    v_cndmask_b32 v246, 0, v246, vcc
    v_cndmask_b32 v244, 0, -1, vcc
    v_mov_b32 v247, 0xff
    v_cndmask_b32 v254, v247, -1, s[58:59]
    v_lshlrev_b32 v7, 3, v7
    v_lshlrev_b32 v251, 4, v9
    v_lshl_add_u32 v252, v8, 13, v251
    v_cmp_gt_u32 vcc, 32, v0
    s_nop 1
    v_cndmask_b32 v252, v11, v252, vcc
    v_lshlrev_b32 v10, 4, v0
    v_cmp_gt_u32 vcc, 56, v0
    s_nop 1
    v_cndmask_b32 v14, v11, v10, vcc
    v_cmp_gt_u32 vcc, 48, v0
    s_nop 1
    v_cndmask_b32 v15, 0, v10, vcc
    s_lshl_b32 s32, s54, 10
    v_add_u32 v240, s32, v10
    v_mov_b32 v28, 0
    v_lshlrev_b32 v241, 2, v0
    v_mov_b32 v242, 1
    v_mov_b32 v36, 0
    v_mov_b32 v37, 0
    v_mov_b32 v38, 0
    v_mov_b32 v39, 0
    v_mov_b32 v40, 0
    v_mov_b32 v41, 0
    v_mov_b32 v42, 0
    v_mov_b32 v43, 0
    v_mov_b32 v44, 0
    v_mov_b32 v45, 0
    v_mov_b32 v46, 0
    v_mov_b32 v47, 0
    v_bfe_i32 v245, v0, 0, 1
    v_xor_b32 v245, s66, v245
    s_cmp_eq_u32 s63, 0
    s_cbranch_scc1 L_owarm
L_owarmed:
    v_and_b32 v9, 3, v0
    v_lshlrev_b32 v9, 3, v9
L_gwait:
    ds_read_b32 v8, v9 offset:4320
    s_waitcnt lgkmcnt(0)
    v_cmp_eq_u32 vcc, -1, v8
    s_bcnt1_i32_b64 s32, vcc
    s_cmp_gt_u32 s32, 32
    s_cselect_b64 vcc, -1, 0
    s_cbranch_vccnz Lg_retry
Lg_ok:
    s_setprio 2
L_items:
    s_waitcnt vmcnt(4)
    buffer_load_dwordx4 v[192:195], v1, s[4:7], s39 offen offset:0 nt
    s_waitcnt vmcnt(4)
    buffer_load_dwordx4 v[196:199], v1, s[4:7], s39 offen offset:128 nt
L_hop17:
    s_cbranch_execz L_hop18
    s_waitcnt vmcnt(4)
    buffer_load_dwordx4 v[200:203], v1, s[4:7], s39 offen offset:256 nt
    s_waitcnt vmcnt(4)
    buffer_load_dwordx4 v[204:207], v1, s[4:7], s39 offen offset:3072 nt
    s_waitcnt vmcnt(4)
    buffer_load_dwordx4 v[208:211], v1, s[4:7], s39 offen offset:3200 nt
    s_waitcnt vmcnt(4)
    buffer_load_dwordx4 v[212:215], v1, s[4:7], s39 offen offset:3328 nt
    s_waitcnt vmcnt(4)
    buffer_load_dwordx4 v[216:219], v2, s[8:11], s39 offen offset:0 nt
    s_waitcnt vmcnt(4)
    buffer_load_dwordx4 v[220:223], v2, s[8:11], s39 offen offset:1536 nt
    s_waitcnt vmcnt(4)
    buffer_load_dwordx4 v[224:227], v2, s[8:11], s39 offen offset:128 nt
    s_waitcnt vmcnt(4)
    buffer_load_dwordx4 v[228:231], v2, s[8:11], s39 offen offset:1664 nt
    s_waitcnt vmcnt(4)
    buffer_load_dwordx4 v[232:235], v2, s[8:11], s39 offen offset:256 nt
    s_waitcnt vmcnt(4)
    buffer_load_dwordx4 v[236:239], v2, s[8:11], s39 offen offset:1792 nt
    v_and_b32 v8, 7, v0
    v_lshlrev_b32 v8, 4, v8
    v_mov_b32 v9, 0
Lqb_loop:
    ds_read_b32 v10, v9 offset:4288
    ds_read_b128 v[16:19], v8 offset:4352
    ds_read_b128 v[20:23], v8 offset:4480
    ds_read_b128 v[24:27], v8 offset:4608
L_hop18:
    s_cbranch_execz L_hop19
    s_waitcnt lgkmcnt(0)
    v_cmp_eq_u32 vcc, -1, v10
    s_cbranch_vccnz Lqb_retry
Lqb_ok:
    v_readfirstlane_b32 s62, v10
    s_cmp_eq_u32 s27, 0
    s_cselect_b32 s32, 0, s62
    s_cmp_eq_u32 s32, 1
    s_cselect_b32 s60, s49, 0x70000000
    s_cselect_b32 s61, 0x70000000, s49
L_bl:
    v_mov_b32 v30, 0
    v_mov_b32 v31, 0
    v_dot2c_f32_bf16 v30, v192, v16
    v_dot2c_f32_bf16 v30, v193, v17
    v_dot2c_f32_bf16 v30, v194, v18
    v_dot2c_f32_bf16 v30, v195, v19
    v_dot2c_f32_bf16 v30, v196, v20
    v_dot2c_f32_bf16 v30, v197, v21
    v_dot2c_f32_bf16 v30, v198, v22
    v_dot2c_f32_bf16 v30, v199, v23
    v_dot2c_f32_bf16 v30, v200, v24
    v_dot2c_f32_bf16 v30, v201, v25
    v_dot2c_f32_bf16 v30, v202, v26
    v_dot2c_f32_bf16 v30, v203, v27
    v_dot2c_f32_bf16 v31, v204, v16
    v_dot2c_f32_bf16 v31, v205, v17
    v_dot2c_f32_bf16 v31, v206, v18
    v_dot2c_f32_bf16 v31, v207, v19
    v_dot2c_f32_bf16 v31, v208, v20
    v_dot2c_f32_bf16 v31, v209, v21
    v_dot2c_f32_bf16 v31, v210, v22
    v_dot2c_f32_bf16 v31, v211, v23
    v_dot2c_f32_bf16 v31, v212, v24
    v_dot2c_f32_bf16 v31, v213, v25
    v_dot2c_f32_bf16 v31, v214, v26
    v_dot2c_f32_bf16 v31, v215, v27
    v_add_f32_dpp v30, v30, v30 row_half_mirror row_mask:0xf bank_mask:0x5
    s_nop 1
    v_add_f32_dpp v30, v31, v31 row_half_mirror row_mask:0xf bank_mask:0xa
    s_nop 1
    v_add_f32_dpp v30, v30, v30 quad_perm:[2,3,0,1] row_mask:0xf bank_mask:0xf
L_hop19:
    s_cbranch_execz L_hop20
    s_nop 0
    v_add_f32_dpp v30, v30, v30 quad_perm:[1,0,3,2] row_mask:0xf bank_mask:0xf
    v_cvt_pk_bf16_f32 v30, 0, v30
    v_mul_f32 v30, 0x3d93cd3a, v30
    v_cvt_pk_bf16_f32 v30, 0, v30
    v_cmp_lt_f32 vcc, s33, v30
    s_sub_u32 s34, s34, 1
    s_mov_b32 s39, s40
    s_mov_b32 s40, s41
    s_mov_b32 s41, s42
    s_mov_b32 s42, s43
    s_mov_b32 s43, s44
    s_mov_b32 s44, s45
    s_cbranch_vccnz L_resc
L_resc_ok:
    v_subrev_f32 v8, s33, v30
    v_mul_f32 v8, 0x3fb8aa3b, v8
    v_exp_f32 v8, v8
    v_mov_b32 v10, s33
    v_add_f32 v28, v28, v8
    v_mov_b32_dpp v9, v8 row_ror:8 row_mask:0xf bank_mask:0xf
    v_cvt_pk_bf16_f32 v9, v8, v9
    s_cmp_eq_u32 s34, 0
    s_nop 0
    v_and_b32_dpp v48, v9, v3 row_newbcast:0 row_mask:0xf bank_mask:0xf
    v_and_b32_dpp v49, v9, v4 row_newbcast:0 row_mask:0xf bank_mask:0xf
    v_and_b32_dpp v50, v9, v3 row_newbcast:4 row_mask:0xf bank_mask:0xf
    v_and_b32_dpp v51, v9, v4 row_newbcast:4 row_mask:0xf bank_mask:0xf
    s_cbranch_scc1 L_btail
    s_cmp_le_u32 s34, s46
    s_cbranch_scc1 L_last
    s_cmp_eq_u32 s37, 1
    s_cbranch_scc1 L_deep
    s_waitcnt vmcnt(4)
    buffer_load_dwordx4 v[192:195], v1, s[4:7], s39 offen offset:0 nt
    v_smfmac_f32_16x16x64_bf16 v[36:39], v[48:51], v[216:223], v5
    s_waitcnt vmcnt(4)
    buffer_load_dwordx4 v[196:199], v1, s[4:7], s39 offen offset:128 nt
    s_waitcnt vmcnt(4)
    buffer_load_dwordx4 v[200:203], v1, s[4:7], s39 offen offset:256 nt
    v_smfmac_f32_16x16x64_bf16 v[40:43], v[48:51], v[224:231], v5
    s_waitcnt vmcnt(4)
    buffer_load_dwordx4 v[204:207], v1, s[4:7], s39 offen offset:3072 nt
L_hop20:
    s_cbranch_execz L_hop21
    s_waitcnt vmcnt(4)
    buffer_load_dwordx4 v[208:211], v1, s[4:7], s39 offen offset:3200 nt
    v_smfmac_f32_16x16x64_bf16 v[44:47], v[48:51], v[232:239], v5
    s_waitcnt vmcnt(4)
    buffer_load_dwordx4 v[212:215], v1, s[4:7], s39 offen offset:3328 nt
    s_waitcnt vmcnt(4)
    buffer_load_dwordx4 v[216:219], v2, s[8:11], s39 offen offset:0 nt
    s_waitcnt vmcnt(4)
    buffer_load_dwordx4 v[220:223], v2, s[8:11], s39 offen offset:1536 nt
    s_waitcnt vmcnt(4)
    buffer_load_dwordx4 v[224:227], v2, s[8:11], s39 offen offset:128 nt
    s_waitcnt vmcnt(4)
    buffer_load_dwordx4 v[228:231], v2, s[8:11], s39 offen offset:1664 nt
    s_waitcnt vmcnt(4)
    buffer_load_dwordx4 v[232:235], v2, s[8:11], s39 offen offset:256 nt
    s_waitcnt vmcnt(4)
    buffer_load_dwordx4 v[236:239], v2, s[8:11], s39 offen offset:1792 nt
    s_branch L_bl
L_deep:
    buffer_load_dwordx4 v[192:195], v1, s[4:7], s39 offen offset:0 nt
    buffer_load_dwordx4 v[196:199], v1, s[4:7], s39 offen offset:128 nt
    buffer_load_dwordx4 v[200:203], v1, s[4:7], s39 offen offset:256 nt
    buffer_load_dwordx4 v[204:207], v1, s[4:7], s39 offen offset:3072 nt
    buffer_load_dwordx4 v[208:211], v1, s[4:7], s39 offen offset:3200 nt
    s_waitcnt vmcnt(10)
    buffer_load_dwordx4 v[212:215], v1, s[4:7], s39 offen offset:3328 nt
    s_waitcnt vmcnt(10)
    v_smfmac_f32_16x16x64_bf16 v[36:39], v[48:51], v[216:223], v5
    buffer_load_dwordx4 v[216:219], v2, s[8:11], s39 offen offset:0 nt
    s_waitcnt vmcnt(10)
    buffer_load_dwordx4 v[220:223], v2, s[8:11], s39 offen offset:1536 nt
    s_waitcnt vmcnt(10)
    v_smfmac_f32_16x16x64_bf16 v[40:43], v[48:51], v[224:231], v5
    buffer_load_dwordx4 v[224:227], v2, s[8:11], s39 offen offset:128 nt
    s_waitcnt vmcnt(10)
    buffer_load_dwordx4 v[228:231], v2, s[8:11], s39 offen offset:1664 nt
    s_waitcnt vmcnt(10)
    v_smfmac_f32_16x16x64_bf16 v[44:47], v[48:51], v[232:239], v5
    buffer_load_dwordx4 v[232:235], v2, s[8:11], s39 offen offset:256 nt
L_hop21:
    s_cbranch_execz L_hop22
    s_waitcnt vmcnt(10)
    buffer_load_dwordx4 v[236:239], v2, s[8:11], s39 offen offset:1792 nt
    s_waitcnt vmcnt(6)
    s_branch L_bl
L_last:
    buffer_load_dwordx4 v[192:195], v1, s[4:7], s39 offen offset:0 nt
    buffer_load_dwordx4 v[196:199], v1, s[4:7], s39 offen offset:128 nt
    s_waitcnt vmcnt(7)
    buffer_load_dwordx4 v[200:203], v1, s[4:7], s39 offen offset:256 nt
    s_waitcnt vmcnt(7)
    buffer_load_dwordx4 v[204:207], v1, s[4:7], s39 offen offset:3072 nt
    v_smfmac_f32_16x16x64_bf16 v[36:39], v[48:51], v[216:223], v5
    s_waitcnt vmcnt(7)
    buffer_load_dwordx4 v[208:211], v1, s[4:7], s39 offen offset:3200 nt
    s_waitcnt vmcnt(7)
    buffer_load_dwordx4 v[212:215], v1, s[4:7], s39 offen offset:3328 nt
    v_smfmac_f32_16x16x64_bf16 v[40:43], v[48:51], v[224:231], v5
    s_waitcnt vmcnt(7)
    buffer_load_dwordx4 v[216:219], v2, s[8:11], s39 offen offset:0 nt
    s_waitcnt vmcnt(7)
    v_smfmac_f32_16x16x64_bf16 v[44:47], v[48:51], v[232:239], v5
    buffer_load_dwordx4 v[220:223], v2, s[8:11], s39 offen offset:1536 nt
    s_waitcnt vmcnt(7)
    buffer_load_dwordx4 v[224:227], v2, s[8:11], s39 offen offset:128 nt
    s_waitcnt vmcnt(7)
    buffer_load_dwordx4 v[228:231], v2, s[8:11], s39 offen offset:1664 nt
    s_waitcnt vmcnt(7)
    buffer_load_dwordx4 v[232:235], v2, s[8:11], s39 offen offset:256 nt
    s_waitcnt vmcnt(7)
    buffer_load_dwordx4 v[236:239], v2, s[8:11], s39 offen offset:1792 nt
    s_waitcnt vmcnt(6)
    s_branch L_bl
L_hop22:
    s_cbranch_execz L_hop23
L_resc:
    v_mov_b32 v8, v30
    s_nop 1
    v_max_f32_dpp v8, v8, v8 row_half_mirror row_mask:0xf bank_mask:0xf
    s_nop 1
    v_max_f32_dpp v8, v8, v8 row_mirror row_mask:0xf bank_mask:0xf
    s_nop 1
    v_max_f32_dpp v8, v8, v8 row_bcast:15 row_mask:0xa bank_mask:0xf
    s_nop 1
    v_max_f32_dpp v8, v8, v8 row_bcast:31 row_mask:0xc bank_mask:0xf
    s_nop 0
    v_readlane_b32 s32, v8, 63
    s_nop 1
    v_mov_b32 v8, s32
    v_sub_f32 v8, s33, v8
    v_mul_f32 v8, 0x3fb8aa3b, v8
    v_exp_f32 v8, v8
    s_mov_b32 s33, s32
    v_mul_f32 v28, v28, v8
    v_pk_mul_f32 v[36:37], v[36:37], v[8:9] op_sel_hi:[1,0]
    v_pk_mul_f32 v[38:39], v[38:39], v[8:9] op_sel_hi:[1,0]
    v_pk_mul_f32 v[40:41], v[40:41], v[8:9] op_sel_hi:[1,0]
    v_pk_mul_f32 v[42:43], v[42:43], v[8:9] op_sel_hi:[1,0]
    v_pk_mul_f32 v[44:45], v[44:45], v[8:9] op_sel_hi:[1,0]
    v_pk_mul_f32 v[46:47], v[46:47], v[8:9] op_sel_hi:[1,0]
    s_branch L_resc_ok
L_btail:
    v_add_f32_dpp v11, v28, v28 row_half_mirror row_mask:0xf bank_mask:0xf
    s_nop 1
    v_add_f32_dpp v11, v11, v11 row_mirror row_mask:0xf bank_mask:0xf
    s_nop 1
    v_add_f32_dpp v11, v11, v11 row_bcast:15 row_mask:0xa bank_mask:0xf
L_hop23:
    s_cbranch_execz L_hop24
    s_nop 0
    v_add_f32_dpp v11, v11, v11 row_bcast:31 row_mask:0xc bank_mask:0xf
    s_mov_b32 exec_lo, 0
    s_mov_b32 exec_hi, 0x80000000
    ds_write_b64 v13, v[10:11] offset:4224
    s_mov_b64 exec, -1
    buffer_load_dwordx4 v[64:67], v29, s[16:19], s51 offen nt
    s_add_u32 s51, s51, 5120
    buffer_load_dwordx4 v[68:71], v29, s[16:19], s52 offen nt
    s_add_u32 s52, s52, 5120
    s_waitcnt vmcnt(7)
    buffer_load_dwordx4 v[72:75], v29, s[16:19], s51 offen nt
    s_add_u32 s51, s51, 5120
    s_waitcnt vmcnt(7)
    v_smfmac_f32_16x16x64_bf16 v[36:39], v[48:51], v[216:223], v5
    ds_read_b64 v[10:11], v7 offset:4224
    ds_read_b128 v[32:35], v240 offset:8192
    buffer_load_dwordx4 v[76:79], v29, s[16:19], s52 offen nt
    s_add_u32 s52, s52, 5120
L_mchk:
    s_waitcnt lgkmcnt(0)
    v_max_f32_dpp v12, v10, v10 quad_perm:[1,0,3,2] row_mask:0xf bank_mask:0xf
    v_cmp_eq_u32 vcc, -1, v10
    s_nop 0
    v_max_f32_dpp v12, v12, v12 quad_perm:[2,3,0,1] row_mask:0xf bank_mask:0xf
    s_nop 1
    v_max_f32_dpp v12, v12, v12 row_half_mirror row_mask:0xf bank_mask:0xf
    v_sub_f32 v8, v10, v12
    v_mul_f32 v8, 0x3fb8aa3b, v8
    v_exp_f32 v8, v8
    s_nop 0
    v_mul_f32 v11, v11, v8
    v_readlane_b32 s56, v8, s54
    v_readlane_b32 s57, v8, s24
    v_add_f32_dpp v11, v11, v11 quad_perm:[1,0,3,2] row_mask:0xf bank_mask:0xf
    s_nop 0
    v_pk_mul_f32 v[32:33], v[32:33], s[56:57] op_sel_hi:[1,0]
    v_pk_mul_f32 v[34:35], v[34:35], s[56:57] op_sel_hi:[1,0]
    v_add_f32_dpp v11, v11, v11 quad_perm:[2,3,0,1] row_mask:0xf bank_mask:0xf
L_hop24:
    s_cbranch_execz L_hop25
    s_nop 0
    v_add_f32_dpp v11, v11, v11 row_half_mirror row_mask:0xf bank_mask:0xf
    s_cbranch_vccnz Lm_retry
Lm_ok:
    s_waitcnt vmcnt(7)
    buffer_load_dwordx4 v[80:83], v29, s[16:19], s51 offen nt
    s_add_u32 s51, s51, 5120
    s_waitcnt vmcnt(7)
    v_smfmac_f32_16x16x64_bf16 v[40:43], v[48:51], v[224:231], v5
    buffer_load_dwordx4 v[84:87], v29, s[16:19], s52 offen nt
    s_add_u32 s52, s52, 5120
    s_waitcnt vmcnt(7)
    buffer_load_dwordx4 v[88:91], v29, s[16:19], s51 offen nt
    s_add_u32 s51, s51, 5120
    s_waitcnt vmcnt(7)
    v_smfmac_f32_16x16x64_bf16 v[44:47], v[48:51], v[232:239], v5
    v_add_f32_dpp v8, v38, v36 row_ror:8 row_mask:0xf bank_mask:0xf
    v_add_f32_dpp v9, v39, v37 row_ror:8 row_mask:0xf bank_mask:0xf
    s_nop 0
    v_add_f32_dpp v8, v40, v42 row_ror:8 row_mask:0xf bank_mask:0xc
    v_add_f32_dpp v9, v41, v43 row_ror:8 row_mask:0xf bank_mask:0xc
    v_pk_fma_f32 v[8:9], v[8:9], s[56:57], v[32:33] op_sel:[0,1,0] op_sel_hi:[1,1,1]
    ds_write_b64 v6, v[8:9]
    s_nop 0
    v_add_f32_dpp v30, v46, v44 row_ror:8 row_mask:0xf bank_mask:0xf
    v_add_f32_dpp v31, v47, v45 row_ror:8 row_mask:0xf bank_mask:0xf
    v_pk_fma_f32 v[30:31], v[30:31], s[56:57], v[34:35] op_sel:[0,1,0] op_sel_hi:[1,1,1]
    ds_write_b64 v243, v[30:31]
    ds_add_rtn_u32 v30, v241, v242 offset:4864
    ds_read_b128 v[48:51], v15 offset:0
    ds_read_b128 v[52:55], v15 offset:768
    ds_read_b128 v[56:59], v15 offset:1536
    ds_read_b128 v[60:63], v15 offset:2304
    v_mov_b32 v36, 0
    v_mov_b32 v37, 0
    v_mov_b32 v38, 0
    v_mov_b32 v39, 0
    v_mov_b32 v31, 0x80000000
    s_cmp_eq_u32 s62, 1
L_hop25:
    s_cbranch_execz L_hop26
    s_waitcnt lgkmcnt(0)
    v_cmp_eq_u32 vcc, 2, v30
    v_pk_add_f32 v[48:49], v[48:49], v[52:53]
    v_pk_add_f32 v[50:51], v[50:51], v[54:55]
    v_pk_add_f32 v[56:57], v[56:57], v[60:61]
    v_pk_add_f32 v[58:59], v[58:59], v[62:63]
    v_pk_add_f32 v[48:49], v[48:49], v[56:57]
    v_pk_add_f32 v[50:51], v[50:51], v[58:59]
    s_cbranch_vccz L_nopub
    v_bfi_b32 v48, v247, s66, v48
    v_bfi_b32 v50, v254, s47, v50
    v_cndmask_b32 v48, v48, v11, s[58:59]
    v_cndmask_b32 v49, v49, v12, s[58:59]
    v_cndmask_b32 v14, v31, v14, vcc
    s_cbranch_scc0 L_pubslow
    buffer_store_dwordx4 v[48:51], v14, s[12:15], s53 offen
L_pubdone:
    ds_write_b32 v36, v242 offset:4312
L_pubseen:
    s_cmp_eq_u32 s18, 0
    s_cbranch_scc1 L_nowo
    buffer_load_dwordx4 v[92:95], v29, s[16:19], s52 offen nt
    s_add_u32 s52, s52, 5120
    buffer_load_dwordx4 v[96:99], v29, s[16:19], s51 offen nt
    s_add_u32 s51, s51, 5120
    buffer_load_dwordx4 v[100:103], v29, s[16:19], s52 offen nt
    s_add_u32 s52, s52, 5120
    buffer_load_dwordx4 v[104:107], v29, s[16:19], s51 offen nt
    buffer_load_dwordx4 v[108:111], v29, s[16:19], s52 offen nt
    s_waitcnt vmcnt(1)
    buffer_load_dwordx4 v[16:19], v253, s[12:15], s49 offen sc1
Lof_a:
    buffer_load_dwordx4 v[20:23], v253, s[12:15], s49 offen sc1
L_hop26:
    s_cbranch_execz L_hop27
    s_waitcnt vmcnt(1)
    v_cmp_ne_u32 vcc, v18, v246
    v_mov_b32 v8, v16
    v_mov_b32 v9, v17
    v_and_b32_dpp v208, v16, v3 row_newbcast:0 row_mask:0xf bank_mask:0xf
    v_and_b32_dpp v209, v16, v4 row_newbcast:0 row_mask:0xf bank_mask:0xf
    v_and_b32_dpp v210, v17, v3 row_newbcast:0 row_mask:0xf bank_mask:0xf
    v_and_b32_dpp v211, v17, v4 row_newbcast:0 row_mask:0xf bank_mask:0xf
    v_and_b32_dpp v212, v16, v3 row_newbcast:1 row_mask:0xf bank_mask:0xf
    v_and_b32_dpp v213, v16, v4 row_newbcast:1 row_mask:0xf bank_mask:0xf
    v_and_b32_dpp v214, v17, v3 row_newbcast:1 row_mask:0xf bank_mask:0xf
    v_and_b32_dpp v215, v17, v4 row_newbcast:1 row_mask:0xf bank_mask:0xf
    s_cbranch_vccnz Lof_b
Lof_go:
    v_smfmac_f32_16x16x64_bf16 v[36:39], v[208:211], v[64:71], v5
    v_and_b32_dpp v216, v8, v3 row_newbcast:2 row_mask:0xf bank_mask:0xf
    v_and_b32_dpp v217, v8, v4 row_newbcast:2 row_mask:0xf bank_mask:0xf
    v_and_b32_dpp v218, v9, v3 row_newbcast:2 row_mask:0xf bank_mask:0xf
    v_and_b32_dpp v219, v9, v4 row_newbcast:2 row_mask:0xf bank_mask:0xf
    v_smfmac_f32_16x16x64_bf16 v[36:39], v[212:215], v[72:79], v5
    v_and_b32_dpp v220, v8, v3 row_newbcast:3 row_mask:0xf bank_mask:0xf
    v_and_b32_dpp v221, v8, v4 row_newbcast:3 row_mask:0xf bank_mask:0xf
    v_and_b32_dpp v222, v9, v3 row_newbcast:3 row_mask:0xf bank_mask:0xf
    v_and_b32_dpp v223, v9, v4 row_newbcast:3 row_mask:0xf bank_mask:0xf
    v_smfmac_f32_16x16x64_bf16 v[36:39], v[216:219], v[80:87], v5
    v_and_b32_dpp v224, v8, v3 row_newbcast:4 row_mask:0xf bank_mask:0xf
    v_and_b32_dpp v225, v8, v4 row_newbcast:4 row_mask:0xf bank_mask:0xf
    v_and_b32_dpp v226, v9, v3 row_newbcast:4 row_mask:0xf bank_mask:0xf
    v_and_b32_dpp v227, v9, v4 row_newbcast:4 row_mask:0xf bank_mask:0xf
    v_smfmac_f32_16x16x64_bf16 v[36:39], v[220:223], v[88:95], v5
    v_and_b32_dpp v228, v8, v3 row_newbcast:5 row_mask:0xf bank_mask:0xf
    v_and_b32_dpp v229, v8, v4 row_newbcast:5 row_mask:0xf bank_mask:0xf
    v_and_b32_dpp v230, v9, v3 row_newbcast:5 row_mask:0xf bank_mask:0xf
    v_and_b32_dpp v231, v9, v4 row_newbcast:5 row_mask:0xf bank_mask:0xf
    v_smfmac_f32_16x16x64_bf16 v[36:39], v[224:227], v[96:103], v5
L_hop27:
    s_cbranch_execz L_hop28
    v_smfmac_f32_16x16x64_bf16 v[36:39], v[228:231], v[104:111], v5
    s_nop 7
    v_add_f32_dpp v10, v38, v36 row_ror:8 row_mask:0xf bank_mask:0xf
    v_add_f32_dpp v11, v39, v37 row_ror:8 row_mask:0xf bank_mask:0xf
    ds_write_b64 v250, v[10:11] offset:9216
    ds_add_rtn_u32 v30, v241, v242 offset:7424
    ds_read_b128 v[48:51], v251 offset:12288
    ds_read_b128 v[52:55], v251 offset:12544
    ds_read_b128 v[56:59], v251 offset:12800
    ds_read_b128 v[60:63], v251 offset:13056
    s_waitcnt lgkmcnt(0)
    v_cmp_eq_u32 vcc, 2, v30
    v_pk_add_f32 v[48:49], v[48:49], v[52:53]
    v_pk_add_f32 v[50:51], v[50:51], v[54:55]
    v_pk_add_f32 v[56:57], v[56:57], v[60:61]
    v_pk_add_f32 v[58:59], v[58:59], v[62:63]
    v_pk_add_f32 v[48:49], v[48:49], v[56:57]
    v_pk_add_f32 v[50:51], v[50:51], v[58:59]
    v_bfi_b32 v48, v247, v245, v48
    v_cndmask_b32 v252, v31, v252, vcc
    buffer_store_dwordx4 v[48:51], v252, s[12:15], s50 offen sc1
    s_endpgm
L_hop28:
    s_cbranch_execz L_hop29
L_nowo:
    s_cmp_lt_u32 s28, 24
    s_cbranch_scc1 L_ffn
    s_cmp_lg_u32 s63, 0
    s_cbranch_scc1 L_hc
L_oload:
    buffer_load_dwordx3 v[10:12], v249, s[12:15], s48 offen offset:768 sc1
    buffer_load_dwordx4 v[192:195], v248, s[12:15], s48 offen offset:0 sc1
    buffer_load_dwordx4 v[196:199], v248, s[12:15], s48 offen offset:1024 sc1
    buffer_load_dwordx4 v[200:203], v248, s[12:15], s48 offen offset:2048 sc1
    buffer_load_dwordx4 v[204:207], v248, s[12:15], s48 offen offset:3072 sc1
    s_waitcnt vmcnt(4)
    v_cmp_ne_u32 s[56:57], s47, v12
    v_max_f32_dpp v12, v11, v11 quad_perm:[1,0,3,2] row_mask:0xf bank_mask:0xf
    s_nop 1
    v_max_f32_dpp v12, v12, v12 quad_perm:[2,3,0,1] row_mask:0xf bank_mask:0xf
    s_nop 1
    v_max_f32_dpp v12, v12, v12 row_ror:8 row_mask:0xf bank_mask:0xf
    v_sub_f32 v12, v11, v12
    v_mul_f32 v12, 0x3fb8aa3b, v12
    v_exp_f32 v12, v12
    s_waitcnt vmcnt(0)
    v_mul_f32 v10, v10, v12
    v_bitop3_b32 v8, v192, v194, s66 bitop3:0xdb
    v_bitop3_b32 v9, v196, v198, s66 bitop3:0xdb
    v_bitop3_b32 v30, v200, v202, s66 bitop3:0xdb
    v_bitop3_b32 v13, v204, v206, s66 bitop3:0xdb
    v_or3_b32 v8, v8, v9, v30
    v_bitop3_b32 v8, v8, v244, v13 bitop3:0xc8
    v_cmp_ne_u32_sdwa vcc, v8, 0 src0_sel:BYTE_0 src1_sel:DWORD
    v_and_b32 v192, s67, v192
    v_and_b32 v194, s67, v194
    v_and_b32 v196, s67, v196
    v_and_b32 v198, s67, v198
    v_and_b32 v200, s67, v200
    v_and_b32 v202, s67, v202
    v_and_b32 v204, s67, v204
    v_and_b32 v206, s67, v206
    s_or_b64 vcc, vcc, s[56:57]
    s_cbranch_vccnz Lo_retry
Lo_ok:
    v_mul_f32_dpp v32, v12, v192 quad_perm:[0,0,0,0] row_mask:0xf bank_mask:0xf
    v_mul_f32_dpp v33, v12, v193 quad_perm:[0,0,0,0] row_mask:0xf bank_mask:0xf
    v_mul_f32_dpp v34, v12, v194 quad_perm:[0,0,0,0] row_mask:0xf bank_mask:0xf
    v_mul_f32_dpp v35, v12, v195 quad_perm:[0,0,0,0] row_mask:0xf bank_mask:0xf
L_hop29:
    s_cbranch_execz L_hop30
    v_add_f32_dpp v10, v10, v10 quad_perm:[1,0,3,2] row_mask:0xf bank_mask:0xf
    v_fmac_f32_dpp v32, v12, v196 quad_perm:[1,1,1,1] row_mask:0xf bank_mask:0xf
    v_fmac_f32_dpp v33, v12, v197 quad_perm:[1,1,1,1] row_mask:0xf bank_mask:0xf
    v_fmac_f32_dpp v34, v12, v198 quad_perm:[1,1,1,1] row_mask:0xf bank_mask:0xf
    v_fmac_f32_dpp v35, v12, v199 quad_perm:[1,1,1,1] row_mask:0xf bank_mask:0xf
    v_add_f32_dpp v10, v10, v10 quad_perm:[2,3,0,1] row_mask:0xf bank_mask:0xf
    v_fmac_f32_dpp v32, v12, v200 quad_perm:[2,2,2,2] row_mask:0xf bank_mask:0xf
    v_fmac_f32_dpp v33, v12, v201 quad_perm:[2,2,2,2] row_mask:0xf bank_mask:0xf
    v_fmac_f32_dpp v34, v12, v202 quad_perm:[2,2,2,2] row_mask:0xf bank_mask:0xf
    v_fmac_f32_dpp v35, v12, v203 quad_perm:[2,2,2,2] row_mask:0xf bank_mask:0xf
    v_add_f32_dpp v10, v10, v10 row_ror:8 row_mask:0xf bank_mask:0xf
    v_fmac_f32_dpp v32, v12, v204 quad_perm:[3,3,3,3] row_mask:0xf bank_mask:0xf
    v_fmac_f32_dpp v33, v12, v205 quad_perm:[3,3,3,3] row_mask:0xf bank_mask:0xf
    v_fmac_f32_dpp v34, v12, v206 quad_perm:[3,3,3,3] row_mask:0xf bank_mask:0xf
    v_fmac_f32_dpp v35, v12, v207 quad_perm:[3,3,3,3] row_mask:0xf bank_mask:0xf
    v_rcp_f32 v10, v10
    v_add_f32_dpp v32, v32, v32 row_ror:8 row_mask:0xf bank_mask:0xf
    v_add_f32_dpp v33, v33, v33 row_ror:8 row_mask:0xf bank_mask:0xf
    v_add_f32_dpp v34, v34, v34 row_ror:8 row_mask:0xf bank_mask:0xf
    v_add_f32_dpp v35, v35, v35 row_ror:8 row_mask:0xf bank_mask:0xf
    v_pk_mul_f32 v[32:33], v[32:33], v[10:11] op_sel_hi:[1,0]
    v_pk_mul_f32 v[34:35], v[34:35], v[10:11] op_sel_hi:[1,0]
    v_cvt_pk_bf16_f32 v8, v32, v33
    v_cvt_pk_bf16_f32 v9, v34, v35
    v_mov_b32 v10, s66
    buffer_store_dwordx4 v[8:11], v253, s[12:15], s60 offen
    buffer_store_dwordx4 v[8:11], v253, s[12:15], s61 offen sc1
L_hc:
    s_cmp_lg_u32 s27, 0
    s_cbranch_scc1 L_exit
    s_cmp_gt_u32 s24, 4
    s_cbranch_scc1 L_exit
    s_mul_i32 s32, s25, 5
    s_add_u32 s32, s32, s24
    s_lshl_b32 s3, s32, 6
    s_lshl_b32 s32, s32, 7
    s_and_b32 s48, s26, 1
    s_lshl_b32 s48, s48, 13
    s_add_u32 s48, s48, s32
L_hop30:
    s_cbranch_execz L_hop31
    s_add_u32 s48, s48, 1048576
    s_add_u32 s49, s32, 294912
    s_cmp_eq_u32 s62, 1
    s_cselect_b32 s60, s49, 0x70000000
    s_cselect_b32 s61, 0x70000000, s49
    v_and_b32 v12, 3, v0
    v_lshrrev_b32 v6, 3, v0
    v_lshlrev_b32 v6, 14, v6
    v_bfe_u32 v7, v0, 2, 1
    v_mul_u32_u24 v7, 2560, v7
    v_lshl_add_u32 v7, v12, 4, v7
    v_add_u32 v6, v6, v7
    v_lshrrev_b32 v7, 5, v0
    v_lshlrev_b32 v7, 1, v7
    v_lshl_add_u32 v12, v12, 2, v7
    v_bfe_u32 v7, v0, 4, 1
    v_add_u32 v12, v12, v7
    v_bfe_u32 v7, v0, 3, 1
    v_lshl_add_u32 v12, v7, 4, v12
    v_lshlrev_b32 v7, 1, v12
    buffer_load_ushort v15, v7, s[20:23], s3 offen
    v_lshlrev_b32 v12, 2, v12
    buffer_load_dword v14, v12, s[12:15], s49 offen sc1
    v_and_b32 v7, 4, v0
    v_cmp_eq_u32 vcc, 0, v7
    v_mov_b32 v7, 0x80000000
L_hop31:
    s_cbranch_execz L_hop32
    v_cndmask_b32 v7, v7, v12, vcc
    v_mov_b32 v12, 0
    v_bfe_i32 v29, v0, 0, 1
    v_xor_b32 v29, s66, v29
    v_bfe_i32 v13, v0, 4, 1
    v_xor_b32 v13, v29, v13
    v_and_b32 v13, 0xffff, v13
Lhp_loop:
    ds_read_b32 v16, v12 offset:4312
    s_waitcnt lgkmcnt(0)
    v_cmp_eq_u32 vcc, -1, v16
    s_cbranch_vccnz Lhp_retry
Lhp_ok:
    s_setprio 2
    s_waitcnt vmcnt(0)
    v_lshlrev_b32 v15, 16, v15
Ly_a:
    buffer_load_dwordx4 v[20:23], v6, s[12:15], s48 offen sc1
    buffer_load_dwordx4 v[24:27], v6, s[12:15], s48 offen offset:64 sc1
    s_waitcnt vmcnt(0)
    v_bitop3_b32 v28, v20, v24, v29 bitop3:0x7e
    v_cmp_ne_u32_sdwa vcc, v28, 0 src0_sel:BYTE_0 src1_sel:DWORD
    v_and_b32 v20, s67, v20
    v_and_b32 v24, s67, v24
    v_permlane32_swap_b32 v21, v23
    v_permlane32_swap_b32 v25, v27
    v_permlane32_swap_b32 v20, v22
    v_permlane32_swap_b32 v24, v26
    v_pk_add_f32 v[16:17], v[20:21], v[22:23]
    v_pk_add_f32 v[18:19], v[24:25], v[26:27]
    s_cbranch_vccnz Ly_retry
Ly_ok:
    v_permlane16_swap_b32 v16, v17
    v_permlane16_swap_b32 v18, v19
    v_add_f32 v16, v16, v17
    v_add_f32 v18, v18, v19
    s_nop 0
    v_add_f32_dpp v17, v16, v16 row_ror:8 row_mask:0xf bank_mask:0xf
    s_nop 1
    v_add_f32_dpp v17, v18, v18 row_ror:8 row_mask:0xf bank_mask:0xc
    s_nop 1
    v_add_f32_dpp v16, v17, v17 row_shl:4 row_mask:0xf bank_mask:0xf
    v_add_f32 v16, v16, v15
    v_cvt_pk_bf16_f32 v16, 0, v16
    v_or_b32 v16, v16, v13
    buffer_store_dword v16, v7, s[12:15], s60 offen
    buffer_store_dword v16, v7, s[12:15], s61 offen sc1
    s_endpgm
L_hop32:
    s_cbranch_execz L_hop33
L_ffn:
    s_load_dwordx2 s[4:5], s[0:1], 48
    s_mov_b32 s6, 1966080
    s_sub_u32 s3, s24, 4
    s_mul_i32 s51, s3, 491520
    s_lshl_b32 s32, s28, 7
    s_add_u32 s51, s51, s32
    s_add_u32 s51, s51, 73728
    s_add_u32 s52, s51, 245760
    v_lshrrev_b32 v8, 5, v0
    v_mul_u32_u24 v8, 40, v8
    v_bfe_u32 v9, v0, 3, 2
    v_add_u32 v8, v8, v9
    v_mul_u32_u24 v8, 3072, v8
    v_and_b32 v9, 7, v0
    v_lshl_add_u32 v28, v9, 4, v8
    v_lshlrev_b32 v9, 5, v9
    v_lshrrev_b32 v8, 4, v0
    v_lshl_add_u32 v9, v8, 3, v9
    s_lshl_b32 s3, s3, 8
    v_add_u32 v9, s3, v9
    v_and_b32 v52, 0x3f803f80, v3
    v_and_b32 v53, 0x3f803f80, v4
    v_and_b32 v54, 0x3f803f80, v3
    v_and_b32 v55, 0x3f803f80, v4
    v_mov_b32 v40, 0
    v_mov_b32 v41, 0
    v_mov_b32 v42, 0
    v_mov_b32 v43, 0
    s_waitcnt lgkmcnt(0)
    s_waitcnt vmcnt(3)
    buffer_load_dwordx4 v[160:163], v28, s[4:7], s51 offen nt
    s_add_u32 s51, s51, 12288
    s_waitcnt vmcnt(3)
    buffer_load_dwordx4 v[164:167], v28, s[4:7], s52 offen nt
    s_add_u32 s52, s52, 12288
    s_waitcnt vmcnt(3)
    buffer_load_dwordx4 v[168:171], v28, s[4:7], s51 offen nt
    s_add_u32 s51, s51, 12288
    s_waitcnt vmcnt(3)
    buffer_load_dwordx4 v[172:175], v28, s[4:7], s52 offen nt
    s_add_u32 s52, s52, 12288
L_hop33:
    s_cbranch_execz L_hop34
    s_waitcnt vmcnt(3)
    buffer_load_dwordx4 v[176:179], v28, s[4:7], s51 offen nt
    s_add_u32 s51, s51, 12288
    s_waitcnt vmcnt(3)
    buffer_load_dwordx4 v[180:183], v28, s[4:7], s52 offen nt
    s_add_u32 s52, s52, 12288
    s_waitcnt vmcnt(3)
    buffer_load_dwordx4 v[184:187], v28, s[4:7], s51 offen nt
    s_waitcnt vmcnt(3)
    buffer_load_dwordx4 v[188:191], v28, s[4:7], s52 offen nt
    v_smfmac_f32_16x16x64_bf16 v[40:43], v[52:55], v[112:119], v5
    v_smfmac_f32_16x16x64_bf16 v[40:43], v[52:55], v[120:127], v5
    v_smfmac_f32_16x16x64_bf16 v[40:43], v[52:55], v[128:135], v5
    v_smfmac_f32_16x16x64_bf16 v[40:43], v[52:55], v[136:143], v5
    v_smfmac_f32_16x16x64_bf16 v[40:43], v[52:55], v[144:151], v5
    v_smfmac_f32_16x16x64_bf16 v[40:43], v[52:55], v[152:159], v5
    v_smfmac_f32_16x16x64_bf16 v[40:43], v[52:55], v[160:167], v5
    v_smfmac_f32_16x16x64_bf16 v[40:43], v[52:55], v[168:175], v5
    s_waitcnt vmcnt(2)
    v_smfmac_f32_16x16x64_bf16 v[40:43], v[52:55], v[176:183], v5
    s_waitcnt vmcnt(0)
    v_smfmac_f32_16x16x64_bf16 v[40:43], v[52:55], v[184:191], v5
    s_nop 7
    v_add_f32_dpp v16, v42, v40 row_ror:8 row_mask:0xf bank_mask:0xf
    v_add_f32_dpp v17, v43, v41 row_ror:8 row_mask:0xf bank_mask:0xf
    s_mov_b32 exec_lo, 0x00ff00ff
    s_mov_b32 exec_hi, 0x00ff00ff
    ds_write_b64 v9, v[16:17] offset:6400
    s_mov_b64 exec, -1
    v_lshrrev_b32 v8, 4, v0
    v_and_b32 v9, 15, v0
    v_mul_u32_u24 v10, 10, v8
    s_mul_i32 s3, s54, 40
    v_add3_u32 v10, v10, v9, s3
    v_lshlrev_b32 v11, 3, v10
    v_lshlrev_b32 v10, 4, v10
    v_mov_b32 v2, 2560
    v_cmp_gt_u32 vcc, 10, v9
L_hop34:
    s_cbranch_execz L_hop35
    s_nop 0
    v_cndmask_b32 v2, v2, v11, vcc
    v_cndmask_b32 v1, v31, v10, vcc
    v_cndmask_b32 v14, 0, -1, vcc
    s_lshl_b32 s32, s54, 5
    v_lshl_add_u32 v8, v8, 3, s32
    v_mov_b32 v6, 3584
    v_cmp_eq_u32 vcc, 0, v9
    s_nop 1
    v_cndmask_b32 v6, v6, v8, vcc
    v_mov_b32 v7, 0x3f803f80
    s_mov_b32 s48, 294912
    s_mov_b32 s49, 0x07060302
    v_mov_b32 v8, 0
Lw2_loop:
    ds_read_b32 v9, v8 offset:4296
    s_waitcnt lgkmcnt(0)
    v_cmp_eq_u32 vcc, -1, v9
    s_cbranch_vccnz Lw2_retry
Lw2_ok:
    buffer_load_dwordx4 v[24:27], v1, s[12:15], s48 offen sc1
Lhh_a:
    buffer_load_dwordx4 v[32:35], v1, s[12:15], s48 offen sc1
    s_waitcnt vmcnt(1)
    v_bitop3_b32 v8, v24, v25, v245 bitop3:0xdb
    v_bitop3_b32 v9, v26, v27, v245 bitop3:0xdb
    v_bitop3_b32 v8, v8, v14, v9 bitop3:0xc8
    v_cmp_ne_u32_sdwa vcc, v8, 0 src0_sel:WORD_0 src1_sel:DWORD
    v_perm_b32 v20, v25, v24, s49
    v_perm_b32 v21, v27, v26, s49
    v_dot2_f32_bf16 v22, v20, v7, 0
    v_dot2_f32_bf16 v23, v20, v20, 0
    v_dot2_f32_bf16 v22, v21, v7, v22
    v_dot2_f32_bf16 v23, v21, v21, v23
    s_cbranch_vccnz Lhh_b
Lhh_go:
    v_and_b32_dpp v48, v20, v3 row_newbcast:0 row_mask:0xf bank_mask:0xf
    v_and_b32_dpp v49, v20, v4 row_newbcast:0 row_mask:0xf bank_mask:0xf
    v_and_b32_dpp v50, v21, v3 row_newbcast:0 row_mask:0xf bank_mask:0xf
    v_add_f32_dpp v22, v22, v22 quad_perm:[1,0,3,2] row_mask:0xf bank_mask:0xf
    v_add_f32_dpp v23, v23, v23 quad_perm:[1,0,3,2] row_mask:0xf bank_mask:0xf
    v_and_b32_dpp v51, v21, v4 row_newbcast:0 row_mask:0xf bank_mask:0xf
L_hop35:
    s_cbranch_execz L_hop36
    v_add_f32_dpp v22, v22, v22 quad_perm:[2,3,0,1] row_mask:0xf bank_mask:0xf
    v_add_f32_dpp v23, v23, v23 quad_perm:[2,3,0,1] row_mask:0xf bank_mask:0xf
    v_smfmac_f32_16x16x64_bf16 v[36:39], v[48:51], v[112:119], v5
    v_add_f32_dpp v22, v22, v22 row_half_mirror row_mask:0xf bank_mask:0xf
    v_add_f32_dpp v23, v23, v23 row_half_mirror row_mask:0xf bank_mask:0xf
    v_and_b32_dpp v52, v20, v3 row_newbcast:1 row_mask:0xf bank_mask:0xf
    v_add_f32_dpp v22, v22, v22 row_mirror row_mask:0xf bank_mask:0xf
    v_add_f32_dpp v23, v23, v23 row_mirror row_mask:0xf bank_mask:0xf
    ds_write_b64 v6, v[22:23] offset:4096
    v_and_b32_dpp v53, v20, v4 row_newbcast:1 row_mask:0xf bank_mask:0xf
    v_and_b32_dpp v54, v21, v3 row_newbcast:1 row_mask:0xf bank_mask:0xf
    v_and_b32_dpp v55, v21, v4 row_newbcast:1 row_mask:0xf bank_mask:0xf
    v_and_b32_dpp v48, v20, v3 row_newbcast:2 row_mask:0xf bank_mask:0xf
    v_and_b32_dpp v49, v20, v4 row_newbcast:2 row_mask:0xf bank_mask:0xf
    v_and_b32_dpp v50, v21, v3 row_newbcast:2 row_mask:0xf bank_mask:0xf
    v_and_b32_dpp v51, v21, v4 row_newbcast:2 row_mask:0xf bank_mask:0xf
    v_smfmac_f32_16x16x64_bf16 v[36:39], v[52:55], v[120:127], v5
    v_and_b32_dpp v52, v20, v3 row_newbcast:3 row_mask:0xf bank_mask:0xf
    v_and_b32_dpp v53, v20, v4 row_newbcast:3 row_mask:0xf bank_mask:0xf
    v_and_b32_dpp v54, v21, v3 row_newbcast:3 row_mask:0xf bank_mask:0xf
    v_and_b32_dpp v55, v21, v4 row_newbcast:3 row_mask:0xf bank_mask:0xf
    v_smfmac_f32_16x16x64_bf16 v[36:39], v[48:51], v[128:135], v5
    v_and_b32_dpp v48, v20, v3 row_newbcast:4 row_mask:0xf bank_mask:0xf
    v_and_b32_dpp v49, v20, v4 row_newbcast:4 row_mask:0xf bank_mask:0xf
    v_and_b32_dpp v50, v21, v3 row_newbcast:4 row_mask:0xf bank_mask:0xf
    v_and_b32_dpp v51, v21, v4 row_newbcast:4 row_mask:0xf bank_mask:0xf
    v_smfmac_f32_16x16x64_bf16 v[36:39], v[52:55], v[136:143], v5
    v_and_b32_dpp v52, v20, v3 row_newbcast:5 row_mask:0xf bank_mask:0xf
    v_and_b32_dpp v53, v20, v4 row_newbcast:5 row_mask:0xf bank_mask:0xf
    v_and_b32_dpp v54, v21, v3 row_newbcast:5 row_mask:0xf bank_mask:0xf
    v_and_b32_dpp v55, v21, v4 row_newbcast:5 row_mask:0xf bank_mask:0xf
L_hop36:
    s_cbranch_execz L_hop37
    v_smfmac_f32_16x16x64_bf16 v[36:39], v[48:51], v[144:151], v5
    v_and_b32_dpp v48, v20, v3 row_newbcast:6 row_mask:0xf bank_mask:0xf
    v_and_b32_dpp v49, v20, v4 row_newbcast:6 row_mask:0xf bank_mask:0xf
    v_and_b32_dpp v50, v21, v3 row_newbcast:6 row_mask:0xf bank_mask:0xf
    v_and_b32_dpp v51, v21, v4 row_newbcast:6 row_mask:0xf bank_mask:0xf
    v_smfmac_f32_16x16x64_bf16 v[36:39], v[52:55], v[152:159], v5
    v_and_b32_dpp v52, v20, v3 row_newbcast:7 row_mask:0xf bank_mask:0xf
    v_and_b32_dpp v53, v20, v4 row_newbcast:7 row_mask:0xf bank_mask:0xf
    v_and_b32_dpp v54, v21, v3 row_newbcast:7 row_mask:0xf bank_mask:0xf
    v_and_b32_dpp v55, v21, v4 row_newbcast:7 row_mask:0xf bank_mask:0xf
    v_smfmac_f32_16x16x64_bf16 v[36:39], v[48:51], v[160:167], v5
    v_and_b32_dpp v48, v20, v3 row_newbcast:8 row_mask:0xf bank_mask:0xf
    v_and_b32_dpp v49, v20, v4 row_newbcast:8 row_mask:0xf bank_mask:0xf
    v_and_b32_dpp v50, v21, v3 row_newbcast:8 row_mask:0xf bank_mask:0xf
    v_and_b32_dpp v51, v21, v4 row_newbcast:8 row_mask:0xf bank_mask:0xf
    v_smfmac_f32_16x16x64_bf16 v[36:39], v[52:55], v[168:175], v5
    v_and_b32_dpp v52, v20, v3 row_newbcast:9 row_mask:0xf bank_mask:0xf
    v_and_b32_dpp v53, v20, v4 row_newbcast:9 row_mask:0xf bank_mask:0xf
    v_and_b32_dpp v54, v21, v3 row_newbcast:9 row_mask:0xf bank_mask:0xf
    v_and_b32_dpp v55, v21, v4 row_newbcast:9 row_mask:0xf bank_mask:0xf
    v_smfmac_f32_16x16x64_bf16 v[36:39], v[48:51], v[176:183], v5
    s_nop 0
    v_smfmac_f32_16x16x64_bf16 v[36:39], v[52:55], v[184:191], v5
    ds_write_b64 v2, v[20:21] offset:5120
    s_nop 6
    v_add_f32_dpp v16, v38, v36 row_ror:8 row_mask:0xf bank_mask:0xf
    v_add_f32_dpp v17, v39, v37 row_ror:8 row_mask:0xf bank_mask:0xf
    ds_write_b64 v250, v[16:17]
    s_branch L_exit
L_hop37:
    s_cbranch_execz L_hop38
L_fin:
    s_load_dwordx2 s[4:5], s[0:1], 56
    s_load_dwordx2 s[8:9], s[0:1], 64
    s_load_dwordx2 s[16:17], s[0:1], 72
    s_load_dwordx2 s[20:21], s[0:1], 80
    s_mov_b32 s6, 3072
    s_mov_b32 s10, 1966080
    s_mov_b32 s18, 1280
    s_cmp_eq_u32 s24, 0
    s_cselect_b32 s29, s28, 99
    s_min_u32 s30, s29, 19
    v_lshrrev_b32 v14, 5, v0
    v_mul_u32_u24 v14, 16, v14
    v_bfe_u32 v15, v0, 3, 2
    v_add_u32 v14, v14, v15
    v_mul_u32_u24 v14, 1280, v14
    v_and_b32 v15, 7, v0
    v_lshl_add_u32 v2, v15, 4, v14
    s_mul_i32 s42, s28, 81920
    s_lshl_b32 s3, s24, 7
    s_add_u32 s42, s42, s3
    s_add_u32 s43, s42, 40960
    v_lshrrev_b32 v6, 4, v0
    v_and_b32 v10, 7, v0
    v_lshl_add_u32 v12, v6, 3, v10
    v_lshlrev_b32 v14, 2, v12
    v_lshlrev_b32 v12, 3, v12
    s_lshl_b32 s32, s30, 5
    v_and_b32 v6, 6, v0
    v_and_b32 v7, 1, v0
    v_lshl_add_u32 v6, v7, 4, v6
    v_lshrrev_b32 v7, 5, v0
    v_lshl_add_u32 v6, v7, 3, v6
    v_bfe_u32 v7, v0, 4, 1
    v_add3_u32 v6, v6, v7, s32
    v_lshlrev_b32 v7, 1, v6
    s_lshl_b32 s32, s28, 7
    s_waitcnt lgkmcnt(0)
    buffer_load_dword v14, v14, s[4:7], s32 offen
    buffer_load_ushort v9, v7, s[16:19], 0 offen
    v_lshlrev_b32 v8, 3, v10
    v_mov_b32 v8, 0
Lpb_loop:
    ds_read_b32 v16, v8 offset:4312
L_hop38:
    s_cbranch_execz L_hop39
    s_waitcnt lgkmcnt(0)
    v_cmp_eq_u32 vcc, -1, v16
    s_cbranch_vccnz Lpb_retry
Lpb_ok:
    s_waitcnt vmcnt(5)
    buffer_load_dwordx4 v[64:67], v2, s[8:11], s42 offen offset:0 nt
    s_waitcnt vmcnt(5)
    buffer_load_dwordx4 v[96:99], v2, s[8:11], s42 offen offset:512 nt
    s_add_u32 s42, s42, 5120
    s_waitcnt vmcnt(5)
    buffer_load_dwordx4 v[68:71], v2, s[8:11], s43 offen offset:0 nt
    s_waitcnt vmcnt(5)
    buffer_load_dwordx4 v[100:103], v2, s[8:11], s43 offen offset:512 nt
    s_add_u32 s43, s43, 5120
    s_waitcnt vmcnt(5)
    buffer_load_dwordx4 v[72:75], v2, s[8:11], s42 offen offset:0 nt
    s_waitcnt vmcnt(5)
    buffer_load_dwordx4 v[104:107], v2, s[8:11], s42 offen offset:512 nt
    s_add_u32 s42, s42, 5120
    s_waitcnt vmcnt(5)
    buffer_load_dwordx4 v[76:79], v2, s[8:11], s43 offen offset:0 nt
    s_waitcnt vmcnt(5)
    buffer_load_dwordx4 v[108:111], v2, s[8:11], s43 offen offset:512 nt
    s_add_u32 s43, s43, 5120
    s_waitcnt vmcnt(5)
    buffer_load_dwordx4 v[80:83], v2, s[8:11], s42 offen offset:0 nt
    s_waitcnt vmcnt(5)
    buffer_load_dwordx4 v[112:115], v2, s[8:11], s42 offen offset:512 nt
    s_add_u32 s42, s42, 5120
    s_waitcnt vmcnt(5)
    buffer_load_dwordx4 v[84:87], v2, s[8:11], s43 offen offset:0 nt
    s_waitcnt vmcnt(5)
    buffer_load_dwordx4 v[116:119], v2, s[8:11], s43 offen offset:512 nt
    s_add_u32 s43, s43, 5120
    s_waitcnt vmcnt(5)
    buffer_load_dwordx4 v[88:91], v2, s[8:11], s42 offen offset:0 nt
    s_waitcnt vmcnt(5)
    buffer_load_dwordx4 v[120:123], v2, s[8:11], s42 offen offset:512 nt
    s_add_u32 s42, s42, 5120
    s_waitcnt vmcnt(5)
    buffer_load_dwordx4 v[92:95], v2, s[8:11], s43 offen offset:0 nt
L_hop39:
    s_cbranch_execz L_hop40
    s_waitcnt vmcnt(5)
    buffer_load_dwordx4 v[124:127], v2, s[8:11], s43 offen offset:512 nt
    s_add_u32 s43, s43, 5120
    s_cmp_ge_u32 s24, 2
    s_cbranch_scc1 L_now2
    s_sub_u32 s42, s42, 5120
    s_waitcnt vmcnt(11)
    buffer_load_dwordx4 v[152:155], v2, s[8:11], s42 offen offset:1024 nt
    s_sub_u32 s43, s43, 5120
    s_waitcnt vmcnt(11)
    buffer_load_dwordx4 v[156:159], v2, s[8:11], s43 offen offset:1024 nt
    s_sub_u32 s42, s42, 5120
    s_waitcnt vmcnt(11)
    buffer_load_dwordx4 v[144:147], v2, s[8:11], s42 offen offset:1024 nt
    s_sub_u32 s43, s43, 5120
    s_waitcnt vmcnt(11)
    buffer_load_dwordx4 v[148:151], v2, s[8:11], s43 offen offset:1024 nt
    s_sub_u32 s42, s42, 5120
    s_waitcnt vmcnt(11)
    buffer_load_dwordx4 v[136:139], v2, s[8:11], s42 offen offset:1024 nt
    s_sub_u32 s43, s43, 5120
    s_waitcnt vmcnt(11)
    buffer_load_dwordx4 v[140:143], v2, s[8:11], s43 offen offset:1024 nt
    s_sub_u32 s42, s42, 5120
    s_waitcnt vmcnt(11)
    buffer_load_dwordx4 v[128:131], v2, s[8:11], s42 offen offset:1024 nt
    s_sub_u32 s43, s43, 5120
L_hop40:
    s_cbranch_execz L_hop41
    s_waitcnt vmcnt(11)
    buffer_load_dwordx4 v[132:135], v2, s[8:11], s43 offen offset:1024 nt
L_now2:
    v_lshlrev_b32 v24, 16, v14
    v_and_b32 v25, 0xffff0000, v14
    v_lshlrev_b32 v9, 16, v9
    v_bfe_u32 v15, v0, 3, 1
    v_lshlrev_b32 v15, 31, v15
    v_or_b32 v6, v7, v15
    s_lshl_b32 s32, s30, 7
    s_add_u32 s49, s32, 327680
    s_add_u32 s50, s49, 5120
    s_xor_b32 s3, s28, 23
    s_or_b32 s3, s3, s24
    s_cselect_b32 s52, 0x70000000, 0
    s_add_u32 s52, s52, 393216
    v_cmp_eq_u32 vcc, 0, v0
    v_mov_b32 v11, 0x80000000
    s_nop 0
    v_cndmask_b32 v11, v11, v0, vcc
    v_mov_b32 v13, s66
    v_mov_b32 v35, 0xff
    s_mul_i32 s40, s28, 2560
    s_add_u32 s40, s40, 327680
    v_and_b32 v1, 3, v0
    v_lshlrev_b32 v1, 3, v1
    v_lshrrev_b32 v2, 4, v0
    v_lshl_add_u32 v1, v2, 5, v1
    v_bfe_u32 v2, v0, 2, 1
    v_lshl_add_u32 v2, v2, 7, v1
    v_bfe_u32 v1, v0, 3, 1
    v_lshl_add_u32 v1, v1, 10, v2
    s_lshl_b32 s32, s24, 8
    v_add_u32 v1, s32, v1
    s_cmp_lt_u32 s24, 2
    s_cselect_b32 s32, s32, 0x70000000
    v_add_u32 v2, s32, v2
    v_or_b32 v2, v2, v15
    v_and_b32 v14, 15, v0
    v_lshlrev_b32 v14, 3, v14
    v_lshrrev_b32 v15, 3, v0
    v_mul_u32_u24 v8, 7680, v15
    v_lshl_add_u32 v8, v10, 4, v8
    buffer_load_dwordx2 v[18:19], v1, s[12:15], s40 offen sc1
L_hop41:
    s_cbranch_execz L_hop42
    buffer_load_dwordx2 v[20:21], v2, s[12:15], s40 offen offset:2048 sc1
    v_bfe_i32 v33, v0, 0, 1
    v_xor_b32 v33, s66, v33
    v_mov_b32 v36, 0
    v_mov_b32 v37, 0
    v_mov_b32 v38, 0
    v_mov_b32 v39, 0
    v_mov_b32 v40, 0
    v_mov_b32 v41, 0
    v_mov_b32 v42, 0
    v_mov_b32 v43, 0
    v_mov_b32 v44, 0
    v_mov_b32 v45, 0
    v_mov_b32 v46, 0
    v_mov_b32 v47, 0
    s_cmp_eq_u32 s24, 0
    s_cselect_b32 s32, 0, 3384
    v_mov_b32 v16, s32
    ds_write_b32 v16, v36 offset:4296
    s_waitcnt vmcnt(0)
L_cswait:
    ds_read_b64 v[16:17], v12 offset:6400
    ds_read_b64 v[18:19], v12 offset:6656
    ds_read_b64 v[20:21], v12 offset:6912
    ds_read_b64 v[22:23], v12 offset:7168
    s_waitcnt lgkmcnt(0)
    v_max3_u32 v29, v16, v18, v20
    v_max_u32 v29, v29, v22
    v_cmp_eq_u32 vcc, -1, v29
    v_pk_add_f32 v[16:17], v[16:17], v[18:19]
    v_pk_add_f32 v[20:21], v[20:21], v[22:23]
    v_pk_add_f32 v[16:17], v[16:17], v[20:21]
    s_cbranch_vccnz Lcs_retry
Lcs_ok:
    v_mov_b32 v26, v16
    v_mov_b32 v27, v17
L_hwait:
    ds_read_b64 v[22:23], v14 offset:4096
    s_waitcnt lgkmcnt(0)
    v_cmp_eq_u32 vcc, -1, v23
    v_add_f32_dpp v22, v22, v22 quad_perm:[1,0,3,2] row_mask:0xf bank_mask:0xf
    v_add_f32_dpp v23, v23, v23 quad_perm:[1,0,3,2] row_mask:0xf bank_mask:0xf
L_hop42:
    s_cbranch_execz L_hop43
    v_add_f32_dpp v22, v22, v22 quad_perm:[2,3,0,1] row_mask:0xf bank_mask:0xf
    v_add_f32_dpp v23, v23, v23 quad_perm:[2,3,0,1] row_mask:0xf bank_mask:0xf
    s_cbranch_vccnz Lh_retry
Lh_ok:
    v_add_f32_dpp v22, v22, v22 row_half_mirror row_mask:0xf bank_mask:0xf
    v_add_f32_dpp v23, v23, v23 row_half_mirror row_mask:0xf bank_mask:0xf
    s_nop 0
    v_add_f32_dpp v22, v22, v22 row_mirror row_mask:0xf bank_mask:0xf
    v_add_f32_dpp v23, v23, v23 row_mirror row_mask:0xf bank_mask:0xf
    v_mul_f32 v28, 0x3acccccd, v22
    v_mul_f32 v30, 0x3acccccd, v23
    v_fma_f32 v30, -v28, v28, v30
    v_cvt_pk_bf16_f32 v28, 0, v28
    v_max_f32 v30, 0, v30
    v_cvt_pk_bf16_f32 v30, 0, v30
    v_add_f32 v30, 0x3727c5ac, v30
    v_cvt_pk_bf16_f32 v30, 0, v30
    v_sqrt_f32 v30, v30
    s_nop 0
    v_cvt_pk_bf16_f32 v30, 0, v30
    v_rcp_f32 v30, v30
    v_pk_mul_f32 v[26:27], v[26:27], v[28:29] op_sel_hi:[1,0]
    v_pk_fma_f32 v[26:27], v[26:27], v[30:31], v[24:25] op_sel_hi:[1,0,1] neg_lo:[1,0,0] neg_hi:[1,0,0]
    buffer_store_dword v13, v11, s[12:15], s52 offen sc1
L_x3wait:
    ds_read_b64 v[16:17], v12 offset:3072
    ds_read_b64 v[18:19], v12 offset:3328
    ds_read_b64 v[20:21], v12 offset:3584
    ds_read_b64 v[22:23], v12 offset:3840
L_hop43:
    s_cbranch_execz L_hop44
    s_waitcnt lgkmcnt(0)
    v_max3_u32 v29, v16, v18, v20
    v_max_u32 v29, v29, v22
    v_cmp_eq_u32 vcc, -1, v29
    v_pk_add_f32 v[16:17], v[16:17], v[18:19]
    v_pk_add_f32 v[20:21], v[20:21], v[22:23]
    v_pk_add_f32 v[16:17], v[16:17], v[20:21]
    v_pk_fma_f32 v[16:17], v[16:17], v[30:31], v[26:27] op_sel_hi:[1,0,1]
    v_max_f32 v16, 0, v16
    v_max_f32 v17, 0, v17
    s_cbranch_vccnz Lx3_retry
Lx3_ok:
    v_pk_mul_f32 v[16:17], v[16:17], v[16:17]
    v_cvt_pk_bf16_f32 v20, v16, v17
    ds_read_u16 v10, v7 offset:5120
    s_cmp_eq_u32 s62, 1
    v_and_b32_dpp v48, v20, v3 row_newbcast:0 row_mask:0xf bank_mask:0xf
    v_and_b32_dpp v49, v20, v4 row_newbcast:0 row_mask:0xf bank_mask:0xf
    v_and_b32_dpp v50, v20, v3 row_newbcast:1 row_mask:0xf bank_mask:0xf
    v_and_b32_dpp v51, v20, v4 row_newbcast:1 row_mask:0xf bank_mask:0xf
    v_and_b32_dpp v52, v20, v3 row_newbcast:2 row_mask:0xf bank_mask:0xf
    v_and_b32_dpp v53, v20, v4 row_newbcast:2 row_mask:0xf bank_mask:0xf
    v_smfmac_f32_16x16x64_bf16 v[36:39], v[48:51], v[64:71], v5
    v_and_b32_dpp v54, v20, v3 row_newbcast:3 row_mask:0xf bank_mask:0xf
    v_and_b32_dpp v55, v20, v4 row_newbcast:3 row_mask:0xf bank_mask:0xf
    v_smfmac_f32_16x16x64_bf16 v[40:43], v[48:51], v[96:103], v5
    v_smfmac_f32_16x16x64_bf16 v[44:47], v[48:51], v[128:135], v5
    v_smfmac_f32_16x16x64_bf16 v[36:39], v[52:55], v[72:79], v5
    v_and_b32_dpp v48, v20, v3 row_newbcast:4 row_mask:0xf bank_mask:0xf
    v_and_b32_dpp v49, v20, v4 row_newbcast:4 row_mask:0xf bank_mask:0xf
    v_smfmac_f32_16x16x64_bf16 v[40:43], v[52:55], v[104:111], v5
    v_and_b32_dpp v50, v20, v3 row_newbcast:5 row_mask:0xf bank_mask:0xf
    v_and_b32_dpp v51, v20, v4 row_newbcast:5 row_mask:0xf bank_mask:0xf
    v_smfmac_f32_16x16x64_bf16 v[44:47], v[52:55], v[136:143], v5
L_hop44:
    s_cbranch_execz L_hop45
    v_smfmac_f32_16x16x64_bf16 v[36:39], v[48:51], v[80:87], v5
    v_and_b32_dpp v52, v20, v3 row_newbcast:6 row_mask:0xf bank_mask:0xf
    v_and_b32_dpp v53, v20, v4 row_newbcast:6 row_mask:0xf bank_mask:0xf
    v_smfmac_f32_16x16x64_bf16 v[40:43], v[48:51], v[112:119], v5
    v_and_b32_dpp v54, v20, v3 row_newbcast:7 row_mask:0xf bank_mask:0xf
    v_and_b32_dpp v55, v20, v4 row_newbcast:7 row_mask:0xf bank_mask:0xf
    v_smfmac_f32_16x16x64_bf16 v[44:47], v[48:51], v[144:151], v5
    s_nop 0
    v_smfmac_f32_16x16x64_bf16 v[36:39], v[52:55], v[88:95], v5
    v_smfmac_f32_16x16x64_bf16 v[40:43], v[52:55], v[120:127], v5
    v_smfmac_f32_16x16x64_bf16 v[44:47], v[52:55], v[152:159], v5
    s_waitcnt lgkmcnt(0)
    v_lshlrev_b32 v10, 16, v10
    v_add_f32 v10, v10, v9
    s_cbranch_scc0 L_zslow
    s_cmp_ge_u32 s24, 2
    s_nop 0
    v_add_f32_dpp v16, v38, v36 row_ror:8 row_mask:0xf bank_mask:0xf
    v_add_f32_dpp v17, v39, v37 row_ror:8 row_mask:0xf bank_mask:0xf
    s_nop 0
    v_add_f32_dpp v16, v40, v42 row_ror:8 row_mask:0xf bank_mask:0xc
    v_add_f32_dpp v17, v41, v43 row_ror:8 row_mask:0xf bank_mask:0xc
    v_bfi_b32 v16, v35, v33, v16
    buffer_store_dwordx2 v[16:17], v1, s[12:15], s40 offen
    s_cbranch_scc1 L_zdone
    v_add_f32_dpp v18, v46, v44 row_ror:8 row_mask:0xf bank_mask:0xf
    v_add_f32_dpp v19, v47, v45 row_ror:8 row_mask:0xf bank_mask:0xf
    v_bfi_b32 v18, v35, v33, v18
    buffer_store_dwordx2 v[18:19], v2, s[12:15], s40 offen offset:2048
L_zdone:
    s_cmp_ge_u32 s29, 20
    s_cbranch_scc1 L_exit
    buffer_load_dwordx4 v[160:163], v8, s[12:15], s49 offen offset:0 sc1
    buffer_load_dwordx4 v[164:167], v8, s[12:15], s49 offen offset:2560 sc1
    buffer_load_dwordx4 v[168:171], v8, s[12:15], s50 offen offset:0 sc1
L_zpoll:
    buffer_load_dwordx4 v[172:175], v8, s[12:15], s49 offen offset:0 sc1
    buffer_load_dwordx4 v[176:179], v8, s[12:15], s49 offen offset:2560 sc1
L_hop45:
    s_cbranch_execz L_hop46
    buffer_load_dwordx4 v[180:183], v8, s[12:15], s50 offen offset:0 sc1
    s_waitcnt vmcnt(3)
    v_bitop3_b32 v16, v160, v162, s66 bitop3:0xdb
    v_bitop3_b32 v17, v164, v166, s66 bitop3:0xdb
    v_bitop3_b32 v18, v168, v170, s66 bitop3:0xdb
    v_or3_b32 v16, v16, v17, v18
    v_cmp_ne_u32_sdwa vcc, v16, 0 src0_sel:BYTE_0 src1_sel:DWORD
    v_and_b32 v160, s67, v160
    v_and_b32 v162, s67, v162
    v_and_b32 v164, s67, v164
    v_and_b32 v166, s67, v166
    v_and_b32 v168, s67, v168
    v_and_b32 v170, s67, v170
    s_cbranch_vccnz L_zb
    v_pk_add_f32 v[48:49], v[160:161], v[164:165]
    v_pk_add_f32 v[50:51], v[162:163], v[166:167]
    v_pk_add_f32 v[48:49], v[48:49], v[168:169]
    v_pk_add_f32 v[50:51], v[50:51], v[170:171]
L_zfin:
    s_nop 1
    v_permlane32_swap_b32 v48, v50
    v_permlane32_swap_b32 v49, v51
    v_pk_add_f32 v[48:49], v[48:49], v[50:51]
    s_nop 1
    v_permlane16_swap_b32 v48, v49
    v_add_f32 v48, v48, v49
    s_nop 1
    v_add_f32_dpp v48, v48, v48 row_ror:8 row_mask:0xf bank_mask:0xf
    v_add_f32 v48, v48, v10
    v_cvt_pk_bf16_f32 v48, v48, v48
    buffer_store_short v48, v6, s[20:23], 0 offen
    s_endpgm
L_hop46:
    s_cbranch_execz L_hop47
L_zb:
    buffer_load_dwordx4 v[160:163], v8, s[12:15], s49 offen offset:0 sc1
    buffer_load_dwordx4 v[164:167], v8, s[12:15], s49 offen offset:2560 sc1
    buffer_load_dwordx4 v[168:171], v8, s[12:15], s50 offen offset:0 sc1
    s_waitcnt vmcnt(3)
    v_bitop3_b32 v16, v172, v174, s66 bitop3:0xdb
    v_bitop3_b32 v17, v176, v178, s66 bitop3:0xdb
    v_bitop3_b32 v18, v180, v182, s66 bitop3:0xdb
    v_or3_b32 v16, v16, v17, v18
    v_cmp_ne_u32_sdwa vcc, v16, 0 src0_sel:BYTE_0 src1_sel:DWORD
    v_and_b32 v172, s67, v172
    v_and_b32 v174, s67, v174
    v_and_b32 v176, s67, v176
    v_and_b32 v178, s67, v178
    v_and_b32 v180, s67, v180
    v_and_b32 v182, s67, v182
    s_cbranch_vccnz Lz_retry
Lz_ok:
    v_pk_add_f32 v[48:49], v[172:173], v[176:177]
    v_pk_add_f32 v[50:51], v[174:175], v[178:179]
    v_pk_add_f32 v[48:49], v[48:49], v[180:181]
    v_pk_add_f32 v[50:51], v[50:51], v[182:183]
    s_nop 0
    s_branch L_zfin
L_zslow:
    s_nop 7
    v_add_f32_dpp v16, v38, v36 row_ror:8 row_mask:0xf bank_mask:0xf
    v_add_f32_dpp v17, v39, v37 row_ror:8 row_mask:0xf bank_mask:0xf
    s_nop 0
    v_add_f32_dpp v16, v40, v42 row_ror:8 row_mask:0xf bank_mask:0xc
    v_add_f32_dpp v17, v41, v43 row_ror:8 row_mask:0xf bank_mask:0xc
    v_bfi_b32 v16, v35, v33, v16
    buffer_store_dwordx2 v[16:17], v1, s[12:15], s40 offen sc1
    v_add_f32_dpp v18, v46, v44 row_ror:8 row_mask:0xf bank_mask:0xf
    v_add_f32_dpp v19, v47, v45 row_ror:8 row_mask:0xf bank_mask:0xf
    v_bfi_b32 v18, v35, v33, v18
    buffer_store_dwordx2 v[18:19], v2, s[12:15], s40 offen offset:2048 sc1
    s_waitcnt vmcnt(0)
    s_branch L_zdone
L_hop47:
    s_cbranch_execz L_hop48
Lof_b:
    buffer_load_dwordx4 v[16:19], v253, s[12:15], s49 offen sc1
    s_waitcnt vmcnt(1)
    v_cmp_ne_u32 vcc, v22, v246
    v_mov_b32 v8, v20
    v_mov_b32 v9, v21
    v_and_b32_dpp v208, v20, v3 row_newbcast:0 row_mask:0xf bank_mask:0xf
    v_and_b32_dpp v209, v20, v4 row_newbcast:0 row_mask:0xf bank_mask:0xf
    v_and_b32_dpp v210, v21, v3 row_newbcast:0 row_mask:0xf bank_mask:0xf
    v_and_b32_dpp v211, v21, v4 row_newbcast:0 row_mask:0xf bank_mask:0xf
    v_and_b32_dpp v212, v20, v3 row_newbcast:1 row_mask:0xf bank_mask:0xf
    v_and_b32_dpp v213, v20, v4 row_newbcast:1 row_mask:0xf bank_mask:0xf
    v_and_b32_dpp v214, v21, v3 row_newbcast:1 row_mask:0xf bank_mask:0xf
    v_and_b32_dpp v215, v21, v4 row_newbcast:1 row_mask:0xf bank_mask:0xf
    s_cbranch_vccnz Lof_retry
Lof_ok:
    s_nop 1
    s_branch Lof_go
Lhh_b:
    buffer_load_dwordx4 v[24:27], v1, s[12:15], s48 offen sc1
    s_waitcnt vmcnt(1)
    v_bitop3_b32 v8, v32, v33, v245 bitop3:0xdb
    v_bitop3_b32 v9, v34, v35, v245 bitop3:0xdb
    v_bitop3_b32 v8, v8, v14, v9 bitop3:0xc8
    v_cmp_ne_u32_sdwa vcc, v8, 0 src0_sel:WORD_0 src1_sel:DWORD
    v_perm_b32 v20, v33, v32, s49
    v_perm_b32 v21, v35, v34, s49
    v_dot2_f32_bf16 v22, v20, v7, 0
    v_dot2_f32_bf16 v23, v20, v20, 0
    v_dot2_f32_bf16 v22, v21, v7, v22
    v_dot2_f32_bf16 v23, v21, v21, v23
    s_cbranch_vccnz Lhh_retry
Lhh_ok:
    s_nop 1
    s_branch Lhh_go
Lcf_retry:
    s_sleep 1
    s_sub_u32 s31, s31, 1
    s_cbranch_scc0 Lcf_loop
    s_mov_b32 s31, 0
    s_branch Lcf_ok
Lqa_retry:
    s_sleep 2
    s_sub_u32 s31, s31, 1
    s_cbranch_scc0 Lqa_loop
    s_mov_b32 s31, 0
    s_branch Lqa_ok
L_hop48:
    s_cbranch_execz L_hop49
Lg00_retry:
    s_sleep 2
    s_sub_u32 s31, s31, 1
    s_cbranch_scc0 Lg00_loop
    s_mov_b32 s31, 0
    s_branch Lg00_ok
Lfl_retry:
    s_sleep 8
    s_sub_u32 s34, s34, 1
    s_cbranch_scc0 L_fwait
    s_branch Lfl_ok
Lg0_retry:
    s_sleep 2
    s_sub_u32 s31, s31, 1
    s_cbranch_scc0 Lg0_loop
    s_mov_b32 s31, 0
    s_branch Lg0_ok
Lqp_retry:
    s_sleep 4
    s_sub_u32 s31, s31, 1
    s_cbranch_scc0 L_qpoll
    s_mov_b32 s31, 0
    s_branch Lqp_ok
L_touch:
    s_mov_b64 exec, 0
    s_branch L_hop0
L_owarm:
    buffer_load_dwordx3 v[64:66], v249, s[12:15], s48 offen offset:768 sc1
    buffer_load_dwordx4 v[192:195], v248, s[12:15], s48 offen offset:0 sc1
    buffer_load_dwordx4 v[196:199], v248, s[12:15], s48 offen offset:1024 sc1
    buffer_load_dwordx4 v[200:203], v248, s[12:15], s48 offen offset:2048 sc1
    buffer_load_dwordx4 v[204:207], v248, s[12:15], s48 offen offset:3072 sc1
    buffer_load_dwordx4 v[68:71], v253, s[12:15], s49 offen sc1
    s_branch L_owarmed
Lg_retry:
    s_sleep 1
    s_sub_u32 s31, s31, 1
    s_cbranch_scc0 L_gwait
    s_mov_b32 s31, 0
    s_branch Lg_ok
Lqb_retry:
    s_sleep 2
    s_sub_u32 s31, s31, 1
    s_cbranch_scc0 Lqb_loop
    s_mov_b32 s31, 0
    s_branch Lqb_ok
Lm_retry:
    s_sub_u32 s31, s31, 1
    s_cbranch_scc1 Lm_give
    ds_read_b64 v[10:11], v7 offset:4224
    ds_read_b128 v[32:35], v240 offset:8192
    s_branch L_mchk
Lm_give:
    s_mov_b32 s31, 0
    s_branch Lm_ok
L_nopub:
    ds_read_b32 v30, v36 offset:4312
    s_waitcnt lgkmcnt(0)
    v_cmp_eq_u32 vcc, -1, v30
    s_cbranch_vccz L_pubseen
    s_sub_u32 s31, s31, 1
    s_cbranch_scc0 L_nopub
    s_mov_b32 s31, 0
    s_branch L_pubseen
L_hop49:
    s_cbranch_execz L_hopend
L_pubslow:
    buffer_store_dwordx4 v[48:51], v14, s[12:15], s53 offen sc1
    s_waitcnt vmcnt(0)
    s_branch L_pubdone
Lo_retry:
    s_sub_u32 s31, s31, 1
    s_cbranch_scc0 L_oload
    s_mov_b32 s31, 0
    s_branch Lo_ok
Lhp_retry:
    s_sleep 4
    s_sub_u32 s31, s31, 1
    s_cbranch_scc0 Lhp_loop
    s_mov_b32 s31, 0
    s_branch Lhp_ok
Ly_retry:
    s_sub_u32 s31, s31, 1
    s_cbranch_scc0 Ly_a
    s_mov_b32 s31, 0
    s_branch Ly_ok
Lw2_retry:
    s_sleep 2
    s_sub_u32 s31, s31, 1
    s_cbranch_scc0 Lw2_loop
    s_mov_b32 s31, 0
    s_branch Lw2_ok
Lpb_retry:
    s_sleep 1
    s_sub_u32 s31, s31, 1
    s_cbranch_scc0 Lpb_loop
    s_mov_b32 s31, 0
    s_branch Lpb_ok
Lcs_retry:
    s_sleep 4
    s_sub_u32 s31, s31, 1
    s_cbranch_scc0 L_cswait
    s_mov_b32 s31, 0
    s_branch Lcs_ok
Lh_retry:
    s_sub_u32 s31, s31, 1
    s_cbranch_scc0 L_hwait
    s_mov_b32 s31, 0
    s_branch Lh_ok
Lx3_retry:
    s_sub_u32 s31, s31, 1
    s_cbranch_scc0 L_x3wait
    s_mov_b32 s31, 0
    s_branch Lx3_ok
Lz_retry:
    s_sub_u32 s31, s31, 1
    s_cbranch_scc0 L_zpoll
    s_mov_b32 s31, 0
    s_branch Lz_ok
Lof_retry:
    s_sub_u32 s31, s31, 1
    s_cbranch_scc0 Lof_a
    s_mov_b32 s31, 0
    s_branch Lof_ok
Lhh_retry:
    s_sub_u32 s31, s31, 1
    s_cbranch_scc0 Lhh_a
    s_mov_b32 s31, 0
    s_branch Lhh_ok
L_exit:
L_end:
    s_endpgm
.section .rodata,"a"
.p2align 6
.amdhsa_kernel sequential_preLN__sliding_block_cached__dense_activation_squared_relu__decode_kernel
  .amdhsa_next_free_vgpr 256
  .amdhsa_next_free_sgpr 102
  .amdhsa_accum_offset 256
  .amdhsa_group_segment_fixed_size 0
  .amdhsa_kernarg_size 104
  .amdhsa_user_sgpr_count 2
  .amdhsa_user_sgpr_kernarg_segment_ptr 1
  .amdhsa_system_sgpr_workgroup_id_x 1
.end_amdhsa_kernel
```
